```python
import torch

def _softmax(x, axis=-1):
    return torch.softmax(x, dim=axis)
def _gelu(x):
    return torch.nn.functional.gelu(x, approximate="tanh")
def _silu(x):
    return torch.nn.functional.silu(x)
def _sigmoid(x):
    return torch.sigmoid(x)
def _layernorm(x, axis=-1, eps=1e-5):
    m = x.mean(dim=axis, keepdim=True)
    v = x.var(dim=axis, keepdim=True, unbiased=False)
    return (x - m) / torch.sqrt(v + eps)
def _scatter_add(tgt, idx, src, axis=0):
    return tgt.clone().index_add_(axis, idx, src)
def _segment_sum(src, seg, n):
    out = torch.zeros((n,) + src.shape[1:], dtype=src.dtype)
    return out.index_add_(0, seg, src)
def _pad(x, pw):
    flat = tuple(v for pair in reversed(pw) for v in pair)
    return torch.nn.functional.pad(x, flat)

kernel_name = 'interleave_layers__ssm_conv_h3__linear_kernel_hedgehog__prompt'

def setup_inputs():

    _w = (lambda a: (lambda t: t.to(torch.bfloat16) if t.is_floating_point() else t)(torch.as_tensor(a)))
    def _A_setup():
        B, S, D = 1, 2048, 1024
        ks = 4
        return {
            "q": _w((lambda *s: torch.randn(*s, dtype=torch.bfloat16) * 0.05)(B, S, D)),
            "k": _w((lambda *s: torch.randn(*s, dtype=torch.bfloat16) * 0.4)(B, S, D)),
            "v": _w((lambda *s: torch.randn(*s, dtype=torch.bfloat16) * 0.4)(B, S, D)),
            "shift_k": _w((lambda *s: torch.randn(*s, dtype=torch.bfloat16) * 0.4)(D, ks) * 0.5),
            "ssm_k": _w((lambda *s: torch.randn(*s, dtype=torch.bfloat16) * 0.4)(D, S) * (1.0 / S ** 0.5)),
            "ssm_D": _w((lambda *s: torch.randn(*s, dtype=torch.bfloat16) * 0.4)(D)),
        }
    _A_in = _A_setup()

    def _B_setup():
        B, S, D, H = 1, 2048, 1024, 32
        Dh = D // H
        return {
            "x": _w((lambda *s: torch.randn(*s, dtype=torch.bfloat16) * 0.05)(B, S, D)),
            "wqkv": _w((lambda *s: torch.randn(*s, dtype=torch.bfloat16) * 0.2)(D, 3 * D)),
            "w_phi": _w((lambda *s: torch.randn(*s, dtype=torch.bfloat16) * 0.2)(H, Dh, Dh) * (Dh ** -0.5)),
            "wo": _w((lambda *s: torch.randn(*s, dtype=torch.bfloat16) * 0.05)(D, D)),
        }
    _B_in = _B_setup()

    return {
        "A_q": _A_in["q"],
        "A_k": _A_in["k"],
        "A_v": _A_in["v"],
        "A_shift_k": _A_in["shift_k"],
        "A_ssm_k": _A_in["ssm_k"],
        "A_ssm_D": _A_in["ssm_D"],
        "B_x": _B_in["x"],
        "B_wqkv": _B_in["wqkv"],
        "B_w_phi": _B_in["w_phi"],
        "B_wo": _B_in["wo"],
    }

def reference(A_q, A_k, A_v, A_shift_k, A_ssm_k, A_ssm_D, B_x, B_wqkv, B_w_phi, B_wo):
    def _A_ref(q, k, v, shift_k, ssm_k, ssm_D):
        B, S, D = q.shape
        ks = shift_k.shape[-1]
        k_pad = _pad(k, ((0, 0), (ks - 1, 0), (0, 0)))
        k_shift = torch.zeros_like(k)
        for t in range(ks):
            k_shift = k_shift + k_pad[:, t:t + S, :] * shift_k[:, ks - 1 - t][None, None, :]
        kv = k_shift * v
        L = 2 * S
        kv_pad = _pad(kv, ((0, 0), (0, S), (0, 0)))
        kf_pad = _pad(ssm_k, ((0, 0), (0, S)))
        kv_f = (lambda x, axes=(-2,-1): torch.fft.rfft2(x.float(), dim=axes))(kv_pad[:, None, :, :], axes=(1, 2))
        kf_f = (lambda x, axes=(-2,-1): torch.fft.rfft2(x.float(), dim=axes))(kf_pad[:, None, :], axes=(1, 2))
        kf_f = (lambda x, *d: x.permute(*d))(kf_f, 1, 2, 0)
        y_f = kv_f * kf_f[None, :, :, :]
        y = (lambda x, s, axes=(-2,-1): torch.fft.irfft2(x, s=s, dim=axes).to(torch.bfloat16))(y_f, (1, L), axes=(1, 2))[:, 0, :S, :]
        y = y + kv * ssm_D[None, None, :]
        return q * y

    def _B_ref(x, wqkv, w_phi, wo):
        B, S, D = x.shape
        H = 32; Dh = D // H
        qkv = (lambda x, *d: x.permute(*d))((x @ wqkv).reshape(B, S, 3, H, Dh), 2, 0, 3, 1, 4)
        q, k, v = qkv[0], qkv[1], qkv[2]
        pq = torch.einsum("bhsd,hdf->bhsf", q, w_phi)
        pk = torch.einsum("bhsd,hdf->bhsf", k, w_phi)
        phi_q = torch.concatenate([_softmax(pq, axis=-1), _softmax(-pq, axis=-1)], axis=-1)
        phi_k = torch.concatenate([_softmax(pk, axis=-1), _softmax(-pk, axis=-1)], axis=-1)
        kv = torch.einsum("bhsf,bhsd->bhfd", phi_k, v)
        z  = torch.einsum("bhsf->bhf", phi_k)
        num = torch.einsum("bhqf,bhfd->bhqd", phi_q, kv)
        den = torch.einsum("bhqf,bhf->bhq", phi_q, z)[..., None] + 1e-6
        o = num / den
        return (lambda x, *d: x.permute(*d))(o, 0, 2, 1, 3).reshape(B, S, D) @ wo

    x = A_q
    x = x + _A_ref(_layernorm(x, axis=-1), A_k, A_v, A_shift_k, A_ssm_k, A_ssm_D)
    x = x + _B_ref(_layernorm(x, axis=-1), B_wqkv, B_w_phi, B_wo)
    x = x + _A_ref(_layernorm(x, axis=-1), A_k, A_v, A_shift_k, A_ssm_k, A_ssm_D)
    x = x + _B_ref(_layernorm(x, axis=-1), B_wqkv, B_w_phi, B_wo)
    return x
```

```asm
; @launch grid=(256,1,1) block=(512,1,1) lds=163840
.amdgcn_target "amdgcn-amd-amdhsa--gfx950"
.text
.globl interleave_layers__ssm_conv_h3__linear_kernel_hedgehog__prompt_kernel
.p2align 8
.type interleave_layers__ssm_conv_h3__linear_kernel_hedgehog__prompt_kernel,@function
interleave_layers__ssm_conv_h3__linear_kernel_hedgehog__prompt_kernel:
    s_cmp_ge_u32 s2, 256
    s_cbranch_scc1 interleave_layers__ssm_conv_h3__linear_kernel_hedgehog__prompt_kernel_end
    s_mov_b32 s32, 0
    s_load_dwordx2 s[4:5], s[0:1], 96
    s_load_dwordx2 s[12:13], s[0:1], 8
    s_load_dwordx2 s[16:17], s[0:1], 16
    s_load_dwordx2 s[20:21], s[0:1], 24
    s_load_dwordx2 s[28:29], s[0:1], 32
    s_getreg_b32 s37, hwreg(HW_REG_XCC_ID, 0, 4)
    v_and_b32 v1, 63, v0
    v_lshrrev_b32 v2, 6, v0
    s_and_b32 s34, s2, 7
    s_lshr_b32 s35, s2, 3
    v_readfirstlane_b32 s33, v2
    s_mov_b32 s39, 0xffff0000
    s_mov_b32 s40, 0x3fb8aa3b
    s_mov_b32 s41, 0xbfb8aa3b
    s_mov_b32 s24, 0x3fb8aa3b
    s_mov_b32 s25, 0x3fb8aa3b
    s_mov_b32 s26, 0xbfb8aa3b
    s_mov_b32 s27, 0xbfb8aa3b
    s_mov_b32 s14, 4194304
    s_mov_b32 s15, 0x20000
    s_mov_b32 s18, 4194304
    s_mov_b32 s19, 0x20000
    s_mov_b32 s22, 8192
    s_mov_b32 s23, 0x20000
    s_mov_b32 s30, 4194304
    s_mov_b32 s31, 0x20000
    v_lshrrev_b32 v3, 4, v1
    v_and_b32 v4, 15, v1
    s_lshl_b32 s48, s35, 6
    s_lshl_b32 s49, s33, 2
    s_add_u32 s48, s48, s49
    v_add_u32 v5, s48, v3
    v_lshlrev_b32 v5, 11, v5
    s_lshl_b32 s49, s34, 8
    v_lshl_add_u32 v6, v4, 4, s49
    v_add_u32 v5, v5, v6
    v_subrev_u32 v6, 6144, v5
    v_add_u32 v7, 65536, v6
    v_add_u32 v8, 131072, v6
    s_lshl_b32 s50, s33, 10
    s_waitcnt lgkmcnt(0)
    s_mov_b32 s8, s4
    s_mov_b32 s9, s5
    s_mov_b32 s10, 67108864
    s_mov_b32 s11, 0x20000
    s_add_u32 s42, s4, 48267264
    s_addc_u32 s43, s5, 0
    s_load_dwordx2 s[6:7], s[42:43], 0
    s_add_u32 m0, s50, 84992
    s_mov_b32 s51, 65536
    buffer_load_dwordx4 v6, s[12:15], 0 offen lds
    s_add_u32 m0, s50, 102400
    s_nop 0
    buffer_load_dwordx4 v5, s[16:19], 0 offen lds
    s_add_u32 m0, s50, 93184
    s_nop 0
    buffer_load_dwordx4 v7, s[12:15], 0 offen lds
    s_add_u32 m0, s50, 110592
    s_nop 0
    buffer_load_dwordx4 v5, s[16:19], s51 offen lds
    s_cmp_lg_u32 s33, 0
    s_cbranch_scc1 Lk174
    s_mov_b32 m0, 101376
    s_nop 0
    buffer_load_dwordx4 v8, s[12:15], 0 offen lds
Lk174:
    v_and_b32 v55, 31, v1
    v_lshrrev_b32 v56, 5, v1
    s_lshl_b32 s49, s34, 10
    v_lshl_add_u32 v9, v55, 5, s49
    buffer_load_dwordx4 v[42:45], v9, s[20:23], 0 offen
    buffer_load_dwordx4 v[46:49], v9, s[20:23], 0 offen offset:16
    s_mul_i32 s42, s34, 786432
    s_lshl_b32 s43, s35, 7
    s_add_u32 s42, s42, s43
    s_mul_i32 s43, s33, 98304
    s_add_u32 s42, s42, s43
    s_add_u32 s42, s42, 0
    v_and_b32 v239, 15, v0
    v_mul_u32_u24 v238, 6144, v239
    v_add_u32 v238, s42, v238
    s_mov_b64 exec, 0xffff
    buffer_load_dword v239, v238, s[8:11], 0 offen sc1
    s_mov_b64 exec, -1
    s_waitcnt lgkmcnt(0)
    s_add_u32 s6, s6, 16
    s_and_b32 s6, s6, -16
    s_add_u32 s7, s7, 1
    s_or_b32 s45, s6, s37
    s_cmp_lg_u32 s33, 0
    s_cbranch_scc1 Lpb5
    s_lshl_b32 s42, s34, 8
    s_lshl_b32 s43, s35, 3
    s_add_u32 s42, s42, s43
    s_add_u32 s42, s42, 48248832
    v_mov_b32 v230, s42
    v_mov_b32 v232, s45
    v_mov_b32 v233, s7
    s_mov_b64 exec, 1
    buffer_store_dwordx2 v[232:233], v230, s[8:11], 0 offen sc1
    s_mov_b64 exec, -1
Lpb5:
    v_lshlrev_b32 v58, 2, v56
    v_sub_u32 v58, v55, v58
    v_mov_b32 v60, 0x3f80
    v_mov_b32 v61, 0x3f800000
    v_cmp_eq_u32 vcc, 0, v58
    v_cmp_eq_u32 s[42:43], 1, v58
    s_nop 0
    v_cndmask_b32 v248, 0, v60, vcc
    v_cndmask_b32 v59, 0, v61, s[42:43]
    v_or_b32 v248, v248, v59
    v_cmp_eq_u32 vcc, 2, v58
    v_cmp_eq_u32 s[42:43], 3, v58
    s_nop 0
    v_cndmask_b32 v249, 0, v60, vcc
    v_cndmask_b32 v59, 0, v61, s[42:43]
    v_or_b32 v249, v249, v59
    v_cmp_eq_u32 vcc, 8, v58
    v_cmp_eq_u32 s[42:43], 9, v58
    s_nop 0
    v_cndmask_b32 v250, 0, v60, vcc
    v_cndmask_b32 v59, 0, v61, s[42:43]
    v_or_b32 v250, v250, v59
    v_cmp_eq_u32 vcc, 10, v58
    v_cmp_eq_u32 s[42:43], 11, v58
    s_nop 0
    v_cndmask_b32 v251, 0, v60, vcc
    v_cndmask_b32 v59, 0, v61, s[42:43]
    v_or_b32 v251, v251, v59
    v_cmp_eq_u32 vcc, 16, v58
    v_cmp_eq_u32 s[42:43], 17, v58
    s_nop 0
    v_cndmask_b32 v252, 0, v60, vcc
    v_cndmask_b32 v59, 0, v61, s[42:43]
    v_or_b32 v252, v252, v59
    v_cmp_eq_u32 vcc, 18, v58
    v_cmp_eq_u32 s[42:43], 19, v58
    s_nop 0
    v_cndmask_b32 v253, 0, v60, vcc
    v_cndmask_b32 v59, 0, v61, s[42:43]
    v_or_b32 v253, v253, v59
    v_cmp_eq_u32 vcc, 24, v58
    v_cmp_eq_u32 s[42:43], 25, v58
    s_nop 0
    v_cndmask_b32 v254, 0, v60, vcc
    v_cndmask_b32 v59, 0, v61, s[42:43]
    v_or_b32 v254, v254, v59
    v_cmp_eq_u32 vcc, 26, v58
    v_cmp_eq_u32 s[42:43], 27, v58
    s_nop 0
    v_cndmask_b32 v255, 0, v60, vcc
    v_cndmask_b32 v59, 0, v61, s[42:43]
    v_or_b32 v255, v255, v59
    s_lshl_b32 s48, s33, 11
    v_lshlrev_b32 v10, 10, v56
    v_lshl_add_u32 v10, v55, 3, v10
    v_add_u32 v10, s48, v10
    v_add_u32 v11, 102400, v10
    v_add_u32 v10, 84992, v10
    s_waitcnt vmcnt(1)
    s_barrier
    v_and_b32 v230, 31, v1
    v_lshlrev_b32 v230, 3, v230
    s_lshl_b32 s42, s34, 8
    s_add_u32 s42, s42, 48248832
    v_add_u32 v230, s42, v230
    buffer_load_dwordx2 v[232:233], v230, s[8:11], 0 offen sc1
    s_and_b32 s51, s33, 3
    s_lshr_b32 s52, s33, 2
    s_lshl_b32 s53, s34, 7
    s_lshl_b32 s54, s35, 2
    s_add_u32 s53, s53, s54
    s_add_u32 s53, s53, s51
    s_lshl_b32 s54, s53, 12
    s_lshl_b32 s55, s52, 11
    s_add_u32 s55, s55, s54
    v_lshlrev_b32 v50, 5, v1
    v_add_u32 v51, s55, v50
    v_subrev_u32 v52, 8, v51
    v_or_b32 v53, s52, v1
    v_cmp_eq_u32 vcc, 0, v53
    v_mov_b32 v54, 0x7ffffff0
    s_nop 0
    v_cndmask_b32 v52, v52, v54, vcc
    buffer_load_dwordx2 v[220:221], v52, s[28:31], 0 offen
    buffer_load_dwordx4 v[222:225], v51, s[28:31], 0 offen
    buffer_load_dwordx4 v[226:229], v51, s[28:31], 0 offen offset:16
    ds_read_b64 v[20:21], v10 offset:0
    ds_read_b64 v[22:23], v10 offset:256
    ds_read_b64 v[24:25], v10 offset:512
    ds_read_b64 v[26:27], v10 offset:768
    ds_read_b64 v[28:29], v10 offset:1024
    ds_read_b64 v[30:31], v10 offset:1280
    ds_read_b64 v[32:33], v10 offset:1536
    ds_read_b64 v[34:35], v11 offset:0
    ds_read_b64 v[36:37], v11 offset:256
    ds_read_b64 v[38:39], v11 offset:512
    ds_read_b64 v[40:41], v11 offset:768
    v_lshlrev_b32 v60, 16, v42
    v_and_b32 v61, s39, v42
    v_lshlrev_b32 v62, 16, v43
    v_and_b32 v63, s39, v43
    v_lshlrev_b32 v64, 16, v44
    v_and_b32 v65, s39, v44
    v_lshlrev_b32 v66, 16, v45
    v_and_b32 v67, s39, v45
    v_lshlrev_b32 v68, 16, v46
    v_and_b32 v69, s39, v46
    v_lshlrev_b32 v70, 16, v47
    v_and_b32 v71, s39, v47
    v_lshlrev_b32 v72, 16, v48
    v_and_b32 v73, s39, v48
    v_lshlrev_b32 v74, 16, v49
    v_and_b32 v75, s39, v49
    s_waitcnt lgkmcnt(0)
    v_lshlrev_b32 v76, 16, v20
    v_and_b32 v77, s39, v20
    v_lshlrev_b32 v78, 16, v21
    v_and_b32 v79, s39, v21
    v_lshlrev_b32 v80, 16, v22
    v_and_b32 v81, s39, v22
    v_lshlrev_b32 v82, 16, v23
    v_and_b32 v83, s39, v23
    v_lshlrev_b32 v84, 16, v24
    v_and_b32 v85, s39, v24
    v_lshlrev_b32 v86, 16, v25
    v_and_b32 v87, s39, v25
    v_lshlrev_b32 v88, 16, v26
    v_and_b32 v89, s39, v26
    v_lshlrev_b32 v90, 16, v27
    v_and_b32 v91, s39, v27
    v_lshlrev_b32 v92, 16, v28
    v_and_b32 v93, s39, v28
    v_lshlrev_b32 v94, 16, v29
    v_and_b32 v95, s39, v29
    v_lshlrev_b32 v96, 16, v30
    v_and_b32 v97, s39, v30
    v_lshlrev_b32 v98, 16, v31
    v_and_b32 v99, s39, v31
    v_lshlrev_b32 v100, 16, v32
    v_and_b32 v101, s39, v32
    v_lshlrev_b32 v102, 16, v33
    v_and_b32 v103, s39, v33
    v_lshlrev_b32 v104, 16, v34
    v_and_b32 v105, s39, v34
    v_lshlrev_b32 v106, 16, v35
    v_and_b32 v107, s39, v35
    v_lshlrev_b32 v108, 16, v36
    v_and_b32 v109, s39, v36
    v_lshlrev_b32 v110, 16, v37
    v_and_b32 v111, s39, v37
    v_lshlrev_b32 v112, 16, v38
    v_and_b32 v113, s39, v38
    v_lshlrev_b32 v114, 16, v39
    v_and_b32 v115, s39, v39
    v_lshlrev_b32 v116, 16, v40
    v_and_b32 v117, s39, v40
    v_lshlrev_b32 v118, 16, v41
    v_and_b32 v119, s39, v41
    v_mul_f32 v120, v76, v63
    v_mul_f32 v121, v77, v67
    v_mul_f32 v122, v78, v71
    v_mul_f32 v123, v79, v75
    v_mul_f32 v124, v80, v63
    v_mul_f32 v125, v81, v67
    v_mul_f32 v126, v82, v71
    v_mul_f32 v127, v83, v75
    v_mul_f32 v128, v84, v63
    v_mul_f32 v129, v85, v67
    v_mul_f32 v130, v86, v71
    v_mul_f32 v131, v87, v75
    v_mul_f32 v132, v88, v63
    v_mul_f32 v133, v89, v67
    v_mul_f32 v134, v90, v71
    v_mul_f32 v135, v91, v75
    v_fmac_f32 v120, v80, v62
    v_fmac_f32 v121, v81, v66
    v_fmac_f32 v122, v82, v70
    v_fmac_f32 v123, v83, v74
    v_fmac_f32 v124, v84, v62
    v_fmac_f32 v125, v85, v66
    v_fmac_f32 v126, v86, v70
    v_fmac_f32 v127, v87, v74
    v_fmac_f32 v128, v88, v62
    v_fmac_f32 v129, v89, v66
    v_fmac_f32 v130, v90, v70
    v_fmac_f32 v131, v91, v74
    v_fmac_f32 v132, v92, v62
    v_fmac_f32 v133, v93, v66
    v_fmac_f32 v134, v94, v70
    v_fmac_f32 v135, v95, v74
    v_fmac_f32 v120, v84, v61
    v_fmac_f32 v121, v85, v65
    v_fmac_f32 v122, v86, v69
    v_fmac_f32 v123, v87, v73
    v_fmac_f32 v124, v88, v61
    v_fmac_f32 v125, v89, v65
    v_fmac_f32 v126, v90, v69
    v_fmac_f32 v127, v91, v73
    v_fmac_f32 v128, v92, v61
    v_fmac_f32 v129, v93, v65
    v_fmac_f32 v130, v94, v69
    v_fmac_f32 v131, v95, v73
    v_fmac_f32 v132, v96, v61
    v_fmac_f32 v133, v97, v65
    v_fmac_f32 v134, v98, v69
    v_fmac_f32 v135, v99, v73
    v_fmac_f32 v120, v88, v60
    v_fmac_f32 v121, v89, v64
    v_fmac_f32 v122, v90, v68
    v_fmac_f32 v123, v91, v72
    v_fmac_f32 v124, v92, v60
    v_fmac_f32 v125, v93, v64
    v_fmac_f32 v126, v94, v68
    v_fmac_f32 v127, v95, v72
    v_fmac_f32 v128, v96, v60
    v_fmac_f32 v129, v97, v64
    v_fmac_f32 v130, v98, v68
    v_fmac_f32 v131, v99, v72
    v_fmac_f32 v132, v100, v60
    v_fmac_f32 v133, v101, v64
    v_fmac_f32 v134, v102, v68
    v_fmac_f32 v135, v103, v72
    v_mul_f32 v120, v120, v104
    v_mul_f32 v121, v121, v105
    v_mul_f32 v122, v122, v106
    v_mul_f32 v123, v123, v107
    v_mul_f32 v124, v124, v108
    v_mul_f32 v125, v125, v109
    v_mul_f32 v126, v126, v110
    v_mul_f32 v127, v127, v111
    v_mul_f32 v128, v128, v112
    v_mul_f32 v129, v129, v113
    v_mul_f32 v130, v130, v114
    v_mul_f32 v131, v131, v115
    v_mul_f32 v132, v132, v116
    v_mul_f32 v133, v133, v117
    v_mul_f32 v134, v134, v118
    v_mul_f32 v135, v135, v119
    v_cvt_pk_bf16_f32 v20, v120, v124
    v_cvt_pk_bf16_f32 v21, v128, v132
    v_cvt_pk_bf16_f32 v22, v121, v125
    v_cvt_pk_bf16_f32 v23, v129, v133
    v_cvt_pk_bf16_f32 v24, v122, v126
    v_cvt_pk_bf16_f32 v25, v130, v134
    v_cvt_pk_bf16_f32 v26, v123, v127
    v_cvt_pk_bf16_f32 v27, v131, v135
    v_and_b32 v12, 7, v55
    v_xor_b32 v12, s33, v12
    v_lshlrev_b32 v12, 4, v12
    v_lshl_add_u32 v12, v56, 3, v12
    v_lshl_add_u32 v12, v55, 9, v12
    v_add_u32 v12, 118784, v12
    ds_write_b64 v12, v[20:21] offset:0
    ds_write_b64 v12, v[22:23] offset:128
    ds_write_b64 v12, v[24:25] offset:256
    ds_write_b64 v12, v[26:27] offset:384
    s_waitcnt vmcnt(3)
    v_and_b32 v231, -16, v232
    v_xor_b32 v231, s6, v231
    v_xor_b32 v234, s7, v233
    v_or_b32 v231, v231, v234
    v_cmp_ne_u32 vcc, 0, v231
    s_cbranch_vccz Lhok6
    v_and_b32 v230, 63, v0
    v_and_b32 v230, 31, v230
    v_lshlrev_b32 v230, 3, v230
    s_lshl_b32 s42, s34, 8
    s_add_u32 s42, s42, 48248832
    v_add_u32 v230, s42, v230
    s_mov_b32 s43, 0
Lpl8:
    buffer_load_dwordx2 v[232:233], v230, s[8:11], 0 offen sc1
    s_add_u32 s43, s43, 1
    s_cmp_gt_u32 s43, 500000
    s_cbranch_scc1 Lwf7
    s_waitcnt vmcnt(0)
    v_and_b32 v231, -16, v232
    v_xor_b32 v231, s6, v231
    v_xor_b32 v234, s7, v233
    v_or_b32 v231, v231, v234
    v_cmp_ne_u32 vcc, 0, v231
    s_cbranch_vccnz Lpl8
Lwf7:
    s_waitcnt vmcnt(0)
Lhok6:
    v_and_b32 v232, 15, v232
    v_cmp_ne_u32 vcc, s37, v232
    s_cmp_eq_u64 vcc, 0
    s_cselect_b32 s36, 1, 0
    v_and_b32 v13, 7, v0
    v_lshrrev_b32 v14, 3, v0
    v_bfe_u32 v15, v14, 2, 3
    v_xor_b32 v15, v15, v13
    v_lshlrev_b32 v15, 4, v15
    v_lshl_add_u32 v15, v14, 7, v15
    v_add_u32 v15, 118784, v15
    s_lshl_b32 s42, s34, 7
    v_add_u32 v16, s42, v14
    v_mul_u32_u24 v16, 6144, v16
    v_lshl_add_u32 v16, v13, 4, v16
    s_lshl_b32 s43, s35, 7
    v_add_u32 v16, s43, v16
    s_waitcnt lgkmcnt(0)
    s_barrier
    s_cmp_ge_u32 s33, 4
    s_cbranch_scc1 Lnst9
    ds_read_b128 v[20:23], v15 offset:0
    ds_read_b128 v[24:27], v15 offset:4096
    ds_read_b128 v[28:31], v15 offset:8192
    ds_read_b128 v[32:35], v15 offset:12288
    s_waitcnt lgkmcnt(0)
    s_cmp_eq_u32 s36, 0
    s_cbranch_scc1 Lst10
    s_mov_b32 s42, 0
    buffer_store_dwordx4 v[20:23], v16, s[8:11], s42 offen
    s_mov_b32 s42, 196608
    buffer_store_dwordx4 v[24:27], v16, s[8:11], s42 offen
    s_mov_b32 s42, 393216
    buffer_store_dwordx4 v[28:31], v16, s[8:11], s42 offen
    s_mov_b32 s42, 589824
    buffer_store_dwordx4 v[32:35], v16, s[8:11], s42 offen
    s_branch Lsd11
Lst10:
    s_mov_b32 s42, 0
    buffer_store_dwordx4 v[20:23], v16, s[8:11], s42 offen sc1
    s_mov_b32 s42, 196608
    buffer_store_dwordx4 v[24:27], v16, s[8:11], s42 offen sc1
    s_mov_b32 s42, 393216
    buffer_store_dwordx4 v[28:31], v16, s[8:11], s42 offen sc1
    s_mov_b32 s42, 589824
    buffer_store_dwordx4 v[32:35], v16, s[8:11], s42 offen sc1
Lsd11:
    s_waitcnt vmcnt(0)
Lnst9:
    s_barrier
    s_cmp_lg_u32 s33, 0
    s_cbranch_scc1 Lpb12
    s_lshl_b32 s42, s34, 8
    s_lshl_b32 s43, s35, 3
    s_add_u32 s42, s42, s43
    s_add_u32 s42, s42, 48234496
    v_mov_b32 v230, s42
    v_mov_b32 v232, s6
    v_mov_b32 v233, s7
    s_mov_b64 exec, 1
    s_cmp_eq_u32 s36, 0
    s_cbranch_scc1 Lst13
    buffer_store_dwordx2 v[232:233], v230, s[8:11], 0 offen
    s_branch Lsd14
Lst13:
    buffer_store_dwordx2 v[232:233], v230, s[8:11], 0 offen sc1
Lsd14:
    s_mov_b64 exec, -1
Lpb12:
    s_mul_i32 s45, s51, 16640
    v_mov_b32 v20, 0
    v_mov_b32 v21, 0
    v_lshrrev_b32 v22, 4, v1
    v_mul_u32_u24 v22, 4160, v22
    v_and_b32 v23, 15, v1
    v_lshl_add_u32 v22, v23, 2, v22
    v_add_u32 v22, s45, v22
    ds_write_b32 v22, v20
    s_mul_i32 s46, s51, 4608
    s_add_u32 s46, s46, 66560
    s_lshl_b32 s47, s52, 8
    s_add_u32 s47, s47, s46
    v_lshl_add_u32 v22, v1, 2, s47
    ds_write_b32 v22, v20
    s_lshl_b32 s47, s52, 11
    s_add_u32 s47, s47, s45
    s_add_u32 s47, s47, 64
    v_lshlrev_b32 v24, 5, v1
    v_add_u32 v24, s47, v24
    s_waitcnt vmcnt(0)
    v_mov_b32 v26, v221
    v_mov_b32 v27, v222
    v_mov_b32 v28, v223
    v_mov_b32 v29, v224
    v_mov_b32 v30, v225
    v_mov_b32 v31, v226
    v_mov_b32 v32, v227
    v_mov_b32 v33, v228
    v_alignbit_b32 v34, v221, v220, 16
    v_alignbit_b32 v35, v222, v221, 16
    v_alignbit_b32 v36, v223, v222, 16
    v_alignbit_b32 v37, v224, v223, 16
    v_alignbit_b32 v38, v225, v224, 16
    v_alignbit_b32 v39, v226, v225, 16
    v_alignbit_b32 v40, v227, v226, 16
    v_alignbit_b32 v41, v228, v227, 16
    v_alignbit_b32 v42, v229, v228, 16
    v_alignbit_b32 v44, v222, v221, 16
    v_alignbit_b32 v45, v223, v222, 16
    v_alignbit_b32 v46, v224, v223, 16
    v_alignbit_b32 v47, v225, v224, 16
    v_alignbit_b32 v48, v226, v225, 16
    v_alignbit_b32 v49, v227, v226, 16
    v_alignbit_b32 v50, v228, v227, 16
    v_alignbit_b32 v51, v229, v228, 16
    ds_write_b128 v24, v[222:225]
    ds_write_b128 v24, v[226:229] offset:16
    ds_write_b128 v24, v[44:47] offset:4160
    ds_write_b128 v24, v[48:51] offset:4176
    ds_write_b128 v24, v[26:29] offset:8320
    ds_write_b128 v24, v[30:33] offset:8336
    ds_write_b128 v24, v[34:37] offset:12480
    ds_write_b128 v24, v[38:41] offset:12496
    s_load_dwordx2 s[42:43], s[0:1], 40
    s_lshr_b32 s44, s53, 1
    s_lshl_b32 s44, s44, 2
    s_waitcnt lgkmcnt(0)
    s_load_dword s38, s[42:43], s44
    s_cmp_lg_u32 s33, 0
    s_cbranch_scc1 Lwo17
    v_and_b32 v200, 63, v0
    v_and_b32 v200, 31, v200
    v_lshlrev_b32 v200, 3, v200
    s_lshl_b32 s42, s34, 8
    s_add_u32 s42, s42, 48234496
    v_add_u32 v200, s42, v200
    s_mov_b32 s43, 0
Lpl20:
    buffer_load_dwordx2 v[202:203], v200, s[8:11], 0 offen sc1
    s_add_u32 s43, s43, 1
    s_cmp_gt_u32 s43, 500000
    s_cbranch_scc1 Lwf19
    s_waitcnt vmcnt(0)
    v_and_b32 v201, -16, v202
    v_xor_b32 v201, s6, v201
    v_xor_b32 v204, s7, v203
    v_or_b32 v201, v201, v204
    v_cmp_ne_u32 vcc, 0, v201
    s_cbranch_vccnz Lpl20
Lwf19:
    s_waitcnt vmcnt(0)
Lwo17:
    s_barrier
    s_load_dwordx2 s[20:21], s[0:1], 0
    s_mov_b32 s22, 4194304
    v_and_b32 v10, 7, v0
    v_lshrrev_b32 v11, 3, v0
    s_lshl_b32 s42, s34, 8
    s_lshl_b32 s43, s35, 3
    s_add_u32 s42, s42, s43
    v_add_u32 v10, s42, v10
    v_lshlrev_b32 v10, 11, v10
    v_lshl_add_u32 v10, v11, 4, v10
    s_cmp_ge_u32 s33, 4
    s_cbranch_scc1 Lnu21
    s_mul_i32 s44, s53, 6144
    s_add_u32 s44, s44, 0
    v_lshl_add_u32 v8, v1, 4, s44
    s_add_u32 m0, s46, 512
    s_nop 0
    buffer_load_dwordx4 v8, s[8:11], 0 offen lds
    buffer_load_dwordx4 v8, s[8:11], 0 offen offset:1024 lds
    buffer_load_dwordx4 v8, s[8:11], 0 offen offset:2048 lds
    buffer_load_dwordx4 v8, s[8:11], 0 offen offset:3072 lds
    s_waitcnt vmcnt(0)
Lnu21:
    s_waitcnt lgkmcnt(0)
    s_barrier
    buffer_load_dwordx4 v[160:163], v10, s[20:23], 0 offen
    buffer_load_dwordx4 v[164:167], v10, s[20:23], 0 offen offset:1024
    s_cmp_ge_u32 s33, 4
    s_cbranch_scc1 Lprep15
    v_lshrrev_b32 v3, 4, v1
    v_bfe_u32 v6, v1, 2, 2
    v_and_b32 v7, 3, v1
    v_mul_u32_u24 v8, 4160, v6
    v_lshlrev_b32 v9, 4, v3
    v_sub_u32 v8, v8, v9
    v_lshl_add_u32 v8, v7, 3, v8
    s_add_u32 s47, s45, 88
    v_add_u32 v2, s47, v8
    v_and_b32 v4, 15, v1
    v_lshlrev_b32 v8, 5, v4
    v_lshl_add_u32 v8, v3, 4, v8
    s_add_u32 s47, s46, 32
    v_add_u32 v5, s47, v8
    v_mov_b32 v8, 0
    v_mov_b32 v9, 0
    v_mov_b32 v10, 0
    v_mov_b32 v11, 0
    v_mov_b32 v12, 0
    v_mov_b32 v13, 0
    v_mov_b32 v14, 0
    v_mov_b32 v15, 0
    v_mov_b32 v16, 0
    v_mov_b32 v17, 0
    v_mov_b32 v18, 0
    v_mov_b32 v19, 0
    v_mov_b32 v20, 0
    v_mov_b32 v21, 0
    v_mov_b32 v22, 0
    v_mov_b32 v23, 0
    v_mov_b32 v24, 0
    v_mov_b32 v25, 0
    v_mov_b32 v26, 0
    v_mov_b32 v27, 0
    v_mov_b32 v28, 0
    v_mov_b32 v29, 0
    v_mov_b32 v30, 0
    v_mov_b32 v31, 0
    v_mov_b32 v32, 0
    v_mov_b32 v33, 0
    v_mov_b32 v34, 0
    v_mov_b32 v35, 0
    v_mov_b32 v36, 0
    v_mov_b32 v37, 0
    v_mov_b32 v38, 0
    v_mov_b32 v39, 0
    ds_read_b64_tr_b16 v[104:105], v2 offset:8
    ds_read_b64_tr_b16 v[106:107], v2 offset:0
    ds_read_b128 v[40:43], v5 offset:448
    ds_read_b128 v[44:47], v5 offset:960
    ds_read_b128 v[48:51], v5 offset:1472
    ds_read_b128 v[52:55], v5 offset:1984
    ds_read_b128 v[56:59], v5 offset:2496
    ds_read_b128 v[60:63], v5 offset:3008
    ds_read_b128 v[64:67], v5 offset:3520
    ds_read_b128 v[68:71], v5 offset:4032
    ds_read_b64_tr_b16 v[108:109], v2 offset:520
    ds_read_b64_tr_b16 v[110:111], v2 offset:512
    ds_read_b64_tr_b16 v[112:113], v2 offset:1032
    ds_read_b64_tr_b16 v[114:115], v2 offset:1024
    ds_read_b128 v[72:75], v5 offset:384
    ds_read_b128 v[76:79], v5 offset:896
    s_waitcnt lgkmcnt(14)
    s_waitcnt lgkmcnt(13)
    v_mfma_f32_16x16x32_bf16 v[8:11], v[104:107], v[40:43], v[8:11]
    s_waitcnt lgkmcnt(12)
    v_mfma_f32_16x16x32_bf16 v[12:15], v[104:107], v[44:47], v[12:15]
    s_waitcnt lgkmcnt(11)
    v_mfma_f32_16x16x32_bf16 v[16:19], v[104:107], v[48:51], v[16:19]
    s_waitcnt lgkmcnt(10)
    v_mfma_f32_16x16x32_bf16 v[20:23], v[104:107], v[52:55], v[20:23]
    s_waitcnt lgkmcnt(9)
    v_mfma_f32_16x16x32_bf16 v[24:27], v[104:107], v[56:59], v[24:27]
    s_waitcnt lgkmcnt(8)
    v_mfma_f32_16x16x32_bf16 v[28:31], v[104:107], v[60:63], v[28:31]
    s_waitcnt lgkmcnt(7)
    v_mfma_f32_16x16x32_bf16 v[32:35], v[104:107], v[64:67], v[32:35]
    s_waitcnt lgkmcnt(6)
    v_mfma_f32_16x16x32_bf16 v[36:39], v[104:107], v[68:71], v[36:39]
    ds_read_b64_tr_b16 v[104:105], v2 offset:1544
    ds_read_b64_tr_b16 v[106:107], v2 offset:1536
    ds_read_b128 v[80:83], v5 offset:1408
    ds_read_b128 v[84:87], v5 offset:1920
    s_waitcnt lgkmcnt(8)
    v_mfma_f32_16x16x32_bf16 v[12:15], v[108:111], v[40:43], v[12:15]
    v_mfma_f32_16x16x32_bf16 v[16:19], v[108:111], v[44:47], v[16:19]
    v_mfma_f32_16x16x32_bf16 v[20:23], v[108:111], v[48:51], v[20:23]
    v_mfma_f32_16x16x32_bf16 v[24:27], v[108:111], v[52:55], v[24:27]
    v_mfma_f32_16x16x32_bf16 v[28:31], v[108:111], v[56:59], v[28:31]
    v_mfma_f32_16x16x32_bf16 v[32:35], v[108:111], v[60:63], v[32:35]
    v_mfma_f32_16x16x32_bf16 v[36:39], v[108:111], v[64:67], v[36:39]
    ds_read_b64_tr_b16 v[108:109], v2 offset:2056
    ds_read_b64_tr_b16 v[110:111], v2 offset:2048
    ds_read_b128 v[88:91], v5 offset:2432
    ds_read_b128 v[92:95], v5 offset:2944
    s_waitcnt lgkmcnt(10)
    v_mfma_f32_16x16x32_bf16 v[16:19], v[112:115], v[40:43], v[16:19]
    v_mfma_f32_16x16x32_bf16 v[20:23], v[112:115], v[44:47], v[20:23]
    v_mfma_f32_16x16x32_bf16 v[24:27], v[112:115], v[48:51], v[24:27]
    v_mfma_f32_16x16x32_bf16 v[28:31], v[112:115], v[52:55], v[28:31]
    v_mfma_f32_16x16x32_bf16 v[32:35], v[112:115], v[56:59], v[32:35]
    v_mfma_f32_16x16x32_bf16 v[36:39], v[112:115], v[60:63], v[36:39]
    ds_read_b64_tr_b16 v[112:113], v2 offset:2568
    ds_read_b64_tr_b16 v[114:115], v2 offset:2560
    ds_read_b128 v[96:99], v5 offset:3456
    ds_read_b128 v[100:103], v5 offset:3968
    s_waitcnt lgkmcnt(10)
    v_mfma_f32_16x16x32_bf16 v[20:23], v[104:107], v[40:43], v[20:23]
    v_mfma_f32_16x16x32_bf16 v[24:27], v[104:107], v[44:47], v[24:27]
    v_mfma_f32_16x16x32_bf16 v[28:31], v[104:107], v[48:51], v[28:31]
    v_mfma_f32_16x16x32_bf16 v[32:35], v[104:107], v[52:55], v[32:35]
    v_mfma_f32_16x16x32_bf16 v[36:39], v[104:107], v[56:59], v[36:39]
    ds_read_b64_tr_b16 v[104:105], v2 offset:3080
    ds_read_b64_tr_b16 v[106:107], v2 offset:3072
    s_waitcnt lgkmcnt(8)
    v_mfma_f32_16x16x32_bf16 v[24:27], v[108:111], v[40:43], v[24:27]
    v_mfma_f32_16x16x32_bf16 v[28:31], v[108:111], v[44:47], v[28:31]
    v_mfma_f32_16x16x32_bf16 v[32:35], v[108:111], v[48:51], v[32:35]
    v_mfma_f32_16x16x32_bf16 v[36:39], v[108:111], v[52:55], v[36:39]
    ds_read_b64_tr_b16 v[108:109], v2 offset:3592
    ds_read_b64_tr_b16 v[110:111], v2 offset:3584
    s_waitcnt lgkmcnt(6)
    v_mfma_f32_16x16x32_bf16 v[28:31], v[112:115], v[40:43], v[28:31]
    v_mfma_f32_16x16x32_bf16 v[32:35], v[112:115], v[44:47], v[32:35]
    v_mfma_f32_16x16x32_bf16 v[36:39], v[112:115], v[48:51], v[36:39]
    ds_read_b64_tr_b16 v[112:113], v2 offset:72
    ds_read_b64_tr_b16 v[114:115], v2 offset:64
    s_waitcnt lgkmcnt(4)
    v_mfma_f32_16x16x32_bf16 v[32:35], v[104:107], v[40:43], v[32:35]
    v_mfma_f32_16x16x32_bf16 v[36:39], v[104:107], v[44:47], v[36:39]
    ds_read_b64_tr_b16 v[104:105], v2 offset:584
    ds_read_b64_tr_b16 v[106:107], v2 offset:576
    s_waitcnt lgkmcnt(4)
    v_mfma_f32_16x16x32_bf16 v[36:39], v[108:111], v[40:43], v[36:39]
    ds_read_b64_tr_b16 v[108:109], v2 offset:1096
    ds_read_b64_tr_b16 v[110:111], v2 offset:1088
    ds_read_b128 v[40:43], v5 offset:320
    ds_read_b128 v[44:47], v5 offset:832
    s_waitcnt lgkmcnt(6)
    v_mfma_f32_16x16x32_bf16 v[8:11], v[112:115], v[72:75], v[8:11]
    v_mfma_f32_16x16x32_bf16 v[12:15], v[112:115], v[76:79], v[12:15]
    v_mfma_f32_16x16x32_bf16 v[16:19], v[112:115], v[80:83], v[16:19]
    v_mfma_f32_16x16x32_bf16 v[20:23], v[112:115], v[84:87], v[20:23]
    v_mfma_f32_16x16x32_bf16 v[24:27], v[112:115], v[88:91], v[24:27]
    v_mfma_f32_16x16x32_bf16 v[28:31], v[112:115], v[92:95], v[28:31]
    v_mfma_f32_16x16x32_bf16 v[32:35], v[112:115], v[96:99], v[32:35]
    v_mfma_f32_16x16x32_bf16 v[36:39], v[112:115], v[100:103], v[36:39]
    ds_read_b64_tr_b16 v[112:113], v2 offset:1608
    ds_read_b64_tr_b16 v[114:115], v2 offset:1600
    ds_read_b128 v[48:51], v5 offset:1344
    ds_read_b128 v[52:55], v5 offset:1856
    s_waitcnt lgkmcnt(8)
    v_mfma_f32_16x16x32_bf16 v[12:15], v[104:107], v[72:75], v[12:15]
    v_mfma_f32_16x16x32_bf16 v[16:19], v[104:107], v[76:79], v[16:19]
    v_mfma_f32_16x16x32_bf16 v[20:23], v[104:107], v[80:83], v[20:23]
    v_mfma_f32_16x16x32_bf16 v[24:27], v[104:107], v[84:87], v[24:27]
    v_mfma_f32_16x16x32_bf16 v[28:31], v[104:107], v[88:91], v[28:31]
    v_mfma_f32_16x16x32_bf16 v[32:35], v[104:107], v[92:95], v[32:35]
    v_mfma_f32_16x16x32_bf16 v[36:39], v[104:107], v[96:99], v[36:39]
    ds_read_b64_tr_b16 v[104:105], v2 offset:2120
    ds_read_b64_tr_b16 v[106:107], v2 offset:2112
    ds_read_b128 v[56:59], v5 offset:2368
    ds_read_b128 v[60:63], v5 offset:2880
    s_waitcnt lgkmcnt(10)
    v_mfma_f32_16x16x32_bf16 v[16:19], v[108:111], v[72:75], v[16:19]
    v_mfma_f32_16x16x32_bf16 v[20:23], v[108:111], v[76:79], v[20:23]
    v_mfma_f32_16x16x32_bf16 v[24:27], v[108:111], v[80:83], v[24:27]
    v_mfma_f32_16x16x32_bf16 v[28:31], v[108:111], v[84:87], v[28:31]
    v_mfma_f32_16x16x32_bf16 v[32:35], v[108:111], v[88:91], v[32:35]
    v_mfma_f32_16x16x32_bf16 v[36:39], v[108:111], v[92:95], v[36:39]
    ds_read_b64_tr_b16 v[108:109], v2 offset:2632
    ds_read_b64_tr_b16 v[110:111], v2 offset:2624
    ds_read_b128 v[64:67], v5 offset:3392
    ds_read_b128 v[68:71], v5 offset:3904
    s_waitcnt lgkmcnt(10)
    v_mfma_f32_16x16x32_bf16 v[20:23], v[112:115], v[72:75], v[20:23]
    v_mfma_f32_16x16x32_bf16 v[24:27], v[112:115], v[76:79], v[24:27]
    v_mfma_f32_16x16x32_bf16 v[28:31], v[112:115], v[80:83], v[28:31]
    v_mfma_f32_16x16x32_bf16 v[32:35], v[112:115], v[84:87], v[32:35]
    v_mfma_f32_16x16x32_bf16 v[36:39], v[112:115], v[88:91], v[36:39]
    ds_read_b64_tr_b16 v[112:113], v2 offset:3144
    ds_read_b64_tr_b16 v[114:115], v2 offset:3136
    s_waitcnt lgkmcnt(8)
    v_mfma_f32_16x16x32_bf16 v[24:27], v[104:107], v[72:75], v[24:27]
    v_mfma_f32_16x16x32_bf16 v[28:31], v[104:107], v[76:79], v[28:31]
    v_mfma_f32_16x16x32_bf16 v[32:35], v[104:107], v[80:83], v[32:35]
    v_mfma_f32_16x16x32_bf16 v[36:39], v[104:107], v[84:87], v[36:39]
    ds_read_b64_tr_b16 v[104:105], v2 offset:3656
    ds_read_b64_tr_b16 v[106:107], v2 offset:3648
    s_waitcnt lgkmcnt(6)
    v_mfma_f32_16x16x32_bf16 v[28:31], v[108:111], v[72:75], v[28:31]
    v_mfma_f32_16x16x32_bf16 v[32:35], v[108:111], v[76:79], v[32:35]
    v_mfma_f32_16x16x32_bf16 v[36:39], v[108:111], v[80:83], v[36:39]
    ds_read_b64_tr_b16 v[108:109], v2 offset:136
    ds_read_b64_tr_b16 v[110:111], v2 offset:128
    s_waitcnt lgkmcnt(4)
    v_mfma_f32_16x16x32_bf16 v[32:35], v[112:115], v[72:75], v[32:35]
    v_mfma_f32_16x16x32_bf16 v[36:39], v[112:115], v[76:79], v[36:39]
    ds_read_b64_tr_b16 v[112:113], v2 offset:648
    ds_read_b64_tr_b16 v[114:115], v2 offset:640
    s_waitcnt lgkmcnt(4)
    v_mfma_f32_16x16x32_bf16 v[36:39], v[104:107], v[72:75], v[36:39]
    ds_read_b64_tr_b16 v[104:105], v2 offset:1160
    ds_read_b64_tr_b16 v[106:107], v2 offset:1152
    ds_read_b128 v[72:75], v5 offset:256
    ds_read_b128 v[76:79], v5 offset:768
    s_waitcnt lgkmcnt(6)
    v_mfma_f32_16x16x32_bf16 v[8:11], v[108:111], v[40:43], v[8:11]
    v_mfma_f32_16x16x32_bf16 v[12:15], v[108:111], v[44:47], v[12:15]
    v_mfma_f32_16x16x32_bf16 v[16:19], v[108:111], v[48:51], v[16:19]
    v_mfma_f32_16x16x32_bf16 v[20:23], v[108:111], v[52:55], v[20:23]
    v_mfma_f32_16x16x32_bf16 v[24:27], v[108:111], v[56:59], v[24:27]
    v_mfma_f32_16x16x32_bf16 v[28:31], v[108:111], v[60:63], v[28:31]
    v_mfma_f32_16x16x32_bf16 v[32:35], v[108:111], v[64:67], v[32:35]
    v_mfma_f32_16x16x32_bf16 v[36:39], v[108:111], v[68:71], v[36:39]
    ds_read_b64_tr_b16 v[108:109], v2 offset:1672
    ds_read_b64_tr_b16 v[110:111], v2 offset:1664
    ds_read_b128 v[80:83], v5 offset:1280
    ds_read_b128 v[84:87], v5 offset:1792
    s_waitcnt lgkmcnt(8)
    v_mfma_f32_16x16x32_bf16 v[12:15], v[112:115], v[40:43], v[12:15]
    v_mfma_f32_16x16x32_bf16 v[16:19], v[112:115], v[44:47], v[16:19]
    v_mfma_f32_16x16x32_bf16 v[20:23], v[112:115], v[48:51], v[20:23]
    v_mfma_f32_16x16x32_bf16 v[24:27], v[112:115], v[52:55], v[24:27]
    v_mfma_f32_16x16x32_bf16 v[28:31], v[112:115], v[56:59], v[28:31]
    v_mfma_f32_16x16x32_bf16 v[32:35], v[112:115], v[60:63], v[32:35]
    v_mfma_f32_16x16x32_bf16 v[36:39], v[112:115], v[64:67], v[36:39]
    ds_read_b64_tr_b16 v[112:113], v2 offset:2184
    ds_read_b64_tr_b16 v[114:115], v2 offset:2176
    ds_read_b128 v[88:91], v5 offset:2304
    ds_read_b128 v[92:95], v5 offset:2816
    s_waitcnt lgkmcnt(10)
    v_mfma_f32_16x16x32_bf16 v[16:19], v[104:107], v[40:43], v[16:19]
    v_mfma_f32_16x16x32_bf16 v[20:23], v[104:107], v[44:47], v[20:23]
    v_mfma_f32_16x16x32_bf16 v[24:27], v[104:107], v[48:51], v[24:27]
    v_mfma_f32_16x16x32_bf16 v[28:31], v[104:107], v[52:55], v[28:31]
    v_mfma_f32_16x16x32_bf16 v[32:35], v[104:107], v[56:59], v[32:35]
    v_mfma_f32_16x16x32_bf16 v[36:39], v[104:107], v[60:63], v[36:39]
    ds_read_b64_tr_b16 v[104:105], v2 offset:2696
    ds_read_b64_tr_b16 v[106:107], v2 offset:2688
    ds_read_b128 v[96:99], v5 offset:3328
    ds_read_b128 v[100:103], v5 offset:3840
    s_waitcnt lgkmcnt(10)
    v_mfma_f32_16x16x32_bf16 v[20:23], v[108:111], v[40:43], v[20:23]
    v_mfma_f32_16x16x32_bf16 v[24:27], v[108:111], v[44:47], v[24:27]
    v_mfma_f32_16x16x32_bf16 v[28:31], v[108:111], v[48:51], v[28:31]
    v_mfma_f32_16x16x32_bf16 v[32:35], v[108:111], v[52:55], v[32:35]
    v_mfma_f32_16x16x32_bf16 v[36:39], v[108:111], v[56:59], v[36:39]
    ds_read_b64_tr_b16 v[108:109], v2 offset:3208
    ds_read_b64_tr_b16 v[110:111], v2 offset:3200
    s_waitcnt lgkmcnt(8)
    v_mfma_f32_16x16x32_bf16 v[24:27], v[112:115], v[40:43], v[24:27]
    v_mfma_f32_16x16x32_bf16 v[28:31], v[112:115], v[44:47], v[28:31]
    v_mfma_f32_16x16x32_bf16 v[32:35], v[112:115], v[48:51], v[32:35]
    v_mfma_f32_16x16x32_bf16 v[36:39], v[112:115], v[52:55], v[36:39]
    ds_read_b64_tr_b16 v[112:113], v2 offset:3720
    ds_read_b64_tr_b16 v[114:115], v2 offset:3712
    s_waitcnt lgkmcnt(6)
    v_mfma_f32_16x16x32_bf16 v[28:31], v[104:107], v[40:43], v[28:31]
    v_mfma_f32_16x16x32_bf16 v[32:35], v[104:107], v[44:47], v[32:35]
    v_mfma_f32_16x16x32_bf16 v[36:39], v[104:107], v[48:51], v[36:39]
    ds_read_b64_tr_b16 v[104:105], v2 offset:200
    ds_read_b64_tr_b16 v[106:107], v2 offset:192
    s_waitcnt lgkmcnt(4)
    v_mfma_f32_16x16x32_bf16 v[32:35], v[108:111], v[40:43], v[32:35]
    v_mfma_f32_16x16x32_bf16 v[36:39], v[108:111], v[44:47], v[36:39]
    ds_read_b64_tr_b16 v[108:109], v2 offset:712
    ds_read_b64_tr_b16 v[110:111], v2 offset:704
    s_waitcnt lgkmcnt(4)
    v_mfma_f32_16x16x32_bf16 v[36:39], v[112:115], v[40:43], v[36:39]
    ds_read_b64_tr_b16 v[112:113], v2 offset:1224
    ds_read_b64_tr_b16 v[114:115], v2 offset:1216
    ds_read_b128 v[40:43], v5 offset:192
    ds_read_b128 v[44:47], v5 offset:704
    s_waitcnt lgkmcnt(6)
    v_mfma_f32_16x16x32_bf16 v[8:11], v[104:107], v[72:75], v[8:11]
    v_mfma_f32_16x16x32_bf16 v[12:15], v[104:107], v[76:79], v[12:15]
    v_mfma_f32_16x16x32_bf16 v[16:19], v[104:107], v[80:83], v[16:19]
    v_mfma_f32_16x16x32_bf16 v[20:23], v[104:107], v[84:87], v[20:23]
    v_mfma_f32_16x16x32_bf16 v[24:27], v[104:107], v[88:91], v[24:27]
    v_mfma_f32_16x16x32_bf16 v[28:31], v[104:107], v[92:95], v[28:31]
    v_mfma_f32_16x16x32_bf16 v[32:35], v[104:107], v[96:99], v[32:35]
    v_mfma_f32_16x16x32_bf16 v[36:39], v[104:107], v[100:103], v[36:39]
    ds_read_b64_tr_b16 v[104:105], v2 offset:1736
    ds_read_b64_tr_b16 v[106:107], v2 offset:1728
    ds_read_b128 v[48:51], v5 offset:1216
    ds_read_b128 v[52:55], v5 offset:1728
    s_waitcnt lgkmcnt(8)
    v_mfma_f32_16x16x32_bf16 v[12:15], v[108:111], v[72:75], v[12:15]
    v_mfma_f32_16x16x32_bf16 v[16:19], v[108:111], v[76:79], v[16:19]
    v_mfma_f32_16x16x32_bf16 v[20:23], v[108:111], v[80:83], v[20:23]
    v_mfma_f32_16x16x32_bf16 v[24:27], v[108:111], v[84:87], v[24:27]
    v_mfma_f32_16x16x32_bf16 v[28:31], v[108:111], v[88:91], v[28:31]
    v_mfma_f32_16x16x32_bf16 v[32:35], v[108:111], v[92:95], v[32:35]
    v_mfma_f32_16x16x32_bf16 v[36:39], v[108:111], v[96:99], v[36:39]
    ds_read_b64_tr_b16 v[108:109], v2 offset:2248
    ds_read_b64_tr_b16 v[110:111], v2 offset:2240
    ds_read_b128 v[56:59], v5 offset:2240
    ds_read_b128 v[60:63], v5 offset:2752
    s_waitcnt lgkmcnt(10)
    v_mfma_f32_16x16x32_bf16 v[16:19], v[112:115], v[72:75], v[16:19]
    v_mfma_f32_16x16x32_bf16 v[20:23], v[112:115], v[76:79], v[20:23]
    v_mfma_f32_16x16x32_bf16 v[24:27], v[112:115], v[80:83], v[24:27]
    v_mfma_f32_16x16x32_bf16 v[28:31], v[112:115], v[84:87], v[28:31]
    v_mfma_f32_16x16x32_bf16 v[32:35], v[112:115], v[88:91], v[32:35]
    v_mfma_f32_16x16x32_bf16 v[36:39], v[112:115], v[92:95], v[36:39]
    ds_read_b64_tr_b16 v[112:113], v2 offset:2760
    ds_read_b64_tr_b16 v[114:115], v2 offset:2752
    ds_read_b128 v[64:67], v5 offset:3264
    ds_read_b128 v[68:71], v5 offset:3776
    s_waitcnt lgkmcnt(10)
    v_mfma_f32_16x16x32_bf16 v[20:23], v[104:107], v[72:75], v[20:23]
    v_mfma_f32_16x16x32_bf16 v[24:27], v[104:107], v[76:79], v[24:27]
    v_mfma_f32_16x16x32_bf16 v[28:31], v[104:107], v[80:83], v[28:31]
    v_mfma_f32_16x16x32_bf16 v[32:35], v[104:107], v[84:87], v[32:35]
    v_mfma_f32_16x16x32_bf16 v[36:39], v[104:107], v[88:91], v[36:39]
    ds_read_b64_tr_b16 v[104:105], v2 offset:3272
    ds_read_b64_tr_b16 v[106:107], v2 offset:3264
    s_waitcnt lgkmcnt(8)
    v_mfma_f32_16x16x32_bf16 v[24:27], v[108:111], v[72:75], v[24:27]
    v_mfma_f32_16x16x32_bf16 v[28:31], v[108:111], v[76:79], v[28:31]
    v_mfma_f32_16x16x32_bf16 v[32:35], v[108:111], v[80:83], v[32:35]
    v_mfma_f32_16x16x32_bf16 v[36:39], v[108:111], v[84:87], v[36:39]
    ds_read_b64_tr_b16 v[108:109], v2 offset:3784
    ds_read_b64_tr_b16 v[110:111], v2 offset:3776
    s_waitcnt lgkmcnt(6)
    v_mfma_f32_16x16x32_bf16 v[28:31], v[112:115], v[72:75], v[28:31]
    v_mfma_f32_16x16x32_bf16 v[32:35], v[112:115], v[76:79], v[32:35]
    v_mfma_f32_16x16x32_bf16 v[36:39], v[112:115], v[80:83], v[36:39]
    ds_read_b64_tr_b16 v[112:113], v2 offset:264
    ds_read_b64_tr_b16 v[114:115], v2 offset:256
    s_waitcnt lgkmcnt(4)
    v_mfma_f32_16x16x32_bf16 v[32:35], v[104:107], v[72:75], v[32:35]
    v_mfma_f32_16x16x32_bf16 v[36:39], v[104:107], v[76:79], v[36:39]
    ds_read_b64_tr_b16 v[104:105], v2 offset:776
    ds_read_b64_tr_b16 v[106:107], v2 offset:768
    s_waitcnt lgkmcnt(4)
    v_mfma_f32_16x16x32_bf16 v[36:39], v[108:111], v[72:75], v[36:39]
    ds_read_b64_tr_b16 v[108:109], v2 offset:1288
    ds_read_b64_tr_b16 v[110:111], v2 offset:1280
    ds_read_b128 v[72:75], v5 offset:128
    ds_read_b128 v[76:79], v5 offset:640
    s_waitcnt lgkmcnt(6)
    v_mfma_f32_16x16x32_bf16 v[8:11], v[112:115], v[40:43], v[8:11]
    v_mfma_f32_16x16x32_bf16 v[12:15], v[112:115], v[44:47], v[12:15]
    v_mfma_f32_16x16x32_bf16 v[16:19], v[112:115], v[48:51], v[16:19]
    v_mfma_f32_16x16x32_bf16 v[20:23], v[112:115], v[52:55], v[20:23]
    v_mfma_f32_16x16x32_bf16 v[24:27], v[112:115], v[56:59], v[24:27]
    v_mfma_f32_16x16x32_bf16 v[28:31], v[112:115], v[60:63], v[28:31]
    v_mfma_f32_16x16x32_bf16 v[32:35], v[112:115], v[64:67], v[32:35]
    v_mfma_f32_16x16x32_bf16 v[36:39], v[112:115], v[68:71], v[36:39]
    ds_read_b64_tr_b16 v[112:113], v2 offset:1800
    ds_read_b64_tr_b16 v[114:115], v2 offset:1792
    ds_read_b128 v[80:83], v5 offset:1152
    ds_read_b128 v[84:87], v5 offset:1664
    s_waitcnt lgkmcnt(8)
    v_mfma_f32_16x16x32_bf16 v[12:15], v[104:107], v[40:43], v[12:15]
    v_mfma_f32_16x16x32_bf16 v[16:19], v[104:107], v[44:47], v[16:19]
    v_mfma_f32_16x16x32_bf16 v[20:23], v[104:107], v[48:51], v[20:23]
    v_mfma_f32_16x16x32_bf16 v[24:27], v[104:107], v[52:55], v[24:27]
    v_mfma_f32_16x16x32_bf16 v[28:31], v[104:107], v[56:59], v[28:31]
    v_mfma_f32_16x16x32_bf16 v[32:35], v[104:107], v[60:63], v[32:35]
    v_mfma_f32_16x16x32_bf16 v[36:39], v[104:107], v[64:67], v[36:39]
    ds_read_b64_tr_b16 v[104:105], v2 offset:2312
    ds_read_b64_tr_b16 v[106:107], v2 offset:2304
    ds_read_b128 v[88:91], v5 offset:2176
    ds_read_b128 v[92:95], v5 offset:2688
    s_waitcnt lgkmcnt(10)
    v_mfma_f32_16x16x32_bf16 v[16:19], v[108:111], v[40:43], v[16:19]
    v_mfma_f32_16x16x32_bf16 v[20:23], v[108:111], v[44:47], v[20:23]
    v_mfma_f32_16x16x32_bf16 v[24:27], v[108:111], v[48:51], v[24:27]
    v_mfma_f32_16x16x32_bf16 v[28:31], v[108:111], v[52:55], v[28:31]
    v_mfma_f32_16x16x32_bf16 v[32:35], v[108:111], v[56:59], v[32:35]
    v_mfma_f32_16x16x32_bf16 v[36:39], v[108:111], v[60:63], v[36:39]
    ds_read_b64_tr_b16 v[108:109], v2 offset:2824
    ds_read_b64_tr_b16 v[110:111], v2 offset:2816
    ds_read_b128 v[96:99], v5 offset:3200
    ds_read_b128 v[100:103], v5 offset:3712
    s_waitcnt lgkmcnt(10)
    v_mfma_f32_16x16x32_bf16 v[20:23], v[112:115], v[40:43], v[20:23]
    v_mfma_f32_16x16x32_bf16 v[24:27], v[112:115], v[44:47], v[24:27]
    v_mfma_f32_16x16x32_bf16 v[28:31], v[112:115], v[48:51], v[28:31]
    v_mfma_f32_16x16x32_bf16 v[32:35], v[112:115], v[52:55], v[32:35]
    v_mfma_f32_16x16x32_bf16 v[36:39], v[112:115], v[56:59], v[36:39]
    ds_read_b64_tr_b16 v[112:113], v2 offset:3336
    ds_read_b64_tr_b16 v[114:115], v2 offset:3328
    s_waitcnt lgkmcnt(8)
    v_mfma_f32_16x16x32_bf16 v[24:27], v[104:107], v[40:43], v[24:27]
    v_mfma_f32_16x16x32_bf16 v[28:31], v[104:107], v[44:47], v[28:31]
    v_mfma_f32_16x16x32_bf16 v[32:35], v[104:107], v[48:51], v[32:35]
    v_mfma_f32_16x16x32_bf16 v[36:39], v[104:107], v[52:55], v[36:39]
    ds_read_b64_tr_b16 v[104:105], v2 offset:3848
    ds_read_b64_tr_b16 v[106:107], v2 offset:3840
    s_waitcnt lgkmcnt(6)
    v_mfma_f32_16x16x32_bf16 v[28:31], v[108:111], v[40:43], v[28:31]
    v_mfma_f32_16x16x32_bf16 v[32:35], v[108:111], v[44:47], v[32:35]
    v_mfma_f32_16x16x32_bf16 v[36:39], v[108:111], v[48:51], v[36:39]
    ds_read_b64_tr_b16 v[108:109], v2 offset:328
    ds_read_b64_tr_b16 v[110:111], v2 offset:320
    s_waitcnt lgkmcnt(4)
    v_mfma_f32_16x16x32_bf16 v[32:35], v[112:115], v[40:43], v[32:35]
    v_mfma_f32_16x16x32_bf16 v[36:39], v[112:115], v[44:47], v[36:39]
    ds_read_b64_tr_b16 v[112:113], v2 offset:840
    ds_read_b64_tr_b16 v[114:115], v2 offset:832
    s_waitcnt lgkmcnt(4)
    v_mfma_f32_16x16x32_bf16 v[36:39], v[104:107], v[40:43], v[36:39]
    ds_read_b64_tr_b16 v[104:105], v2 offset:1352
    ds_read_b64_tr_b16 v[106:107], v2 offset:1344
    ds_read_b128 v[40:43], v5 offset:64
    ds_read_b128 v[44:47], v5 offset:576
    s_waitcnt lgkmcnt(6)
    v_mfma_f32_16x16x32_bf16 v[8:11], v[108:111], v[72:75], v[8:11]
    v_mfma_f32_16x16x32_bf16 v[12:15], v[108:111], v[76:79], v[12:15]
    v_mfma_f32_16x16x32_bf16 v[16:19], v[108:111], v[80:83], v[16:19]
    v_mfma_f32_16x16x32_bf16 v[20:23], v[108:111], v[84:87], v[20:23]
    v_mfma_f32_16x16x32_bf16 v[24:27], v[108:111], v[88:91], v[24:27]
    v_mfma_f32_16x16x32_bf16 v[28:31], v[108:111], v[92:95], v[28:31]
    v_mfma_f32_16x16x32_bf16 v[32:35], v[108:111], v[96:99], v[32:35]
    v_mfma_f32_16x16x32_bf16 v[36:39], v[108:111], v[100:103], v[36:39]
    ds_read_b64_tr_b16 v[108:109], v2 offset:1864
    ds_read_b64_tr_b16 v[110:111], v2 offset:1856
    ds_read_b128 v[48:51], v5 offset:1088
    ds_read_b128 v[52:55], v5 offset:1600
    s_waitcnt lgkmcnt(8)
    v_mfma_f32_16x16x32_bf16 v[12:15], v[112:115], v[72:75], v[12:15]
    v_mfma_f32_16x16x32_bf16 v[16:19], v[112:115], v[76:79], v[16:19]
    v_mfma_f32_16x16x32_bf16 v[20:23], v[112:115], v[80:83], v[20:23]
    v_mfma_f32_16x16x32_bf16 v[24:27], v[112:115], v[84:87], v[24:27]
    v_mfma_f32_16x16x32_bf16 v[28:31], v[112:115], v[88:91], v[28:31]
    v_mfma_f32_16x16x32_bf16 v[32:35], v[112:115], v[92:95], v[32:35]
    v_mfma_f32_16x16x32_bf16 v[36:39], v[112:115], v[96:99], v[36:39]
    ds_read_b64_tr_b16 v[112:113], v2 offset:2376
    ds_read_b64_tr_b16 v[114:115], v2 offset:2368
    ds_read_b128 v[56:59], v5 offset:2112
    ds_read_b128 v[60:63], v5 offset:2624
    s_waitcnt lgkmcnt(10)
    v_mfma_f32_16x16x32_bf16 v[16:19], v[104:107], v[72:75], v[16:19]
    v_mfma_f32_16x16x32_bf16 v[20:23], v[104:107], v[76:79], v[20:23]
    v_mfma_f32_16x16x32_bf16 v[24:27], v[104:107], v[80:83], v[24:27]
    v_mfma_f32_16x16x32_bf16 v[28:31], v[104:107], v[84:87], v[28:31]
    v_mfma_f32_16x16x32_bf16 v[32:35], v[104:107], v[88:91], v[32:35]
    v_mfma_f32_16x16x32_bf16 v[36:39], v[104:107], v[92:95], v[36:39]
    ds_read_b64_tr_b16 v[104:105], v2 offset:2888
    ds_read_b64_tr_b16 v[106:107], v2 offset:2880
    ds_read_b128 v[64:67], v5 offset:3136
    ds_read_b128 v[68:71], v5 offset:3648
    s_waitcnt lgkmcnt(10)
    v_mfma_f32_16x16x32_bf16 v[20:23], v[108:111], v[72:75], v[20:23]
    v_mfma_f32_16x16x32_bf16 v[24:27], v[108:111], v[76:79], v[24:27]
    v_mfma_f32_16x16x32_bf16 v[28:31], v[108:111], v[80:83], v[28:31]
    v_mfma_f32_16x16x32_bf16 v[32:35], v[108:111], v[84:87], v[32:35]
    v_mfma_f32_16x16x32_bf16 v[36:39], v[108:111], v[88:91], v[36:39]
    ds_read_b64_tr_b16 v[108:109], v2 offset:3400
    ds_read_b64_tr_b16 v[110:111], v2 offset:3392
    s_waitcnt lgkmcnt(8)
    v_mfma_f32_16x16x32_bf16 v[24:27], v[112:115], v[72:75], v[24:27]
    v_mfma_f32_16x16x32_bf16 v[28:31], v[112:115], v[76:79], v[28:31]
    v_mfma_f32_16x16x32_bf16 v[32:35], v[112:115], v[80:83], v[32:35]
    v_mfma_f32_16x16x32_bf16 v[36:39], v[112:115], v[84:87], v[36:39]
    ds_read_b64_tr_b16 v[112:113], v2 offset:3912
    ds_read_b64_tr_b16 v[114:115], v2 offset:3904
    s_waitcnt lgkmcnt(6)
    v_mfma_f32_16x16x32_bf16 v[28:31], v[104:107], v[72:75], v[28:31]
    v_mfma_f32_16x16x32_bf16 v[32:35], v[104:107], v[76:79], v[32:35]
    v_mfma_f32_16x16x32_bf16 v[36:39], v[104:107], v[80:83], v[36:39]
    ds_read_b64_tr_b16 v[104:105], v2 offset:392
    ds_read_b64_tr_b16 v[106:107], v2 offset:384
    s_waitcnt lgkmcnt(4)
    v_mfma_f32_16x16x32_bf16 v[32:35], v[108:111], v[72:75], v[32:35]
    v_mfma_f32_16x16x32_bf16 v[36:39], v[108:111], v[76:79], v[36:39]
    ds_read_b64_tr_b16 v[108:109], v2 offset:904
    ds_read_b64_tr_b16 v[110:111], v2 offset:896
    s_waitcnt lgkmcnt(4)
    v_mfma_f32_16x16x32_bf16 v[36:39], v[112:115], v[72:75], v[36:39]
    ds_read_b64_tr_b16 v[112:113], v2 offset:1416
    ds_read_b64_tr_b16 v[114:115], v2 offset:1408
    ds_read_b128 v[72:75], v5 offset:0
    ds_read_b128 v[76:79], v5 offset:512
    s_waitcnt lgkmcnt(6)
    v_mfma_f32_16x16x32_bf16 v[8:11], v[104:107], v[40:43], v[8:11]
    v_mfma_f32_16x16x32_bf16 v[12:15], v[104:107], v[44:47], v[12:15]
    v_mfma_f32_16x16x32_bf16 v[16:19], v[104:107], v[48:51], v[16:19]
    v_mfma_f32_16x16x32_bf16 v[20:23], v[104:107], v[52:55], v[20:23]
    v_mfma_f32_16x16x32_bf16 v[24:27], v[104:107], v[56:59], v[24:27]
    v_mfma_f32_16x16x32_bf16 v[28:31], v[104:107], v[60:63], v[28:31]
    v_mfma_f32_16x16x32_bf16 v[32:35], v[104:107], v[64:67], v[32:35]
    v_mfma_f32_16x16x32_bf16 v[36:39], v[104:107], v[68:71], v[36:39]
    ds_read_b64_tr_b16 v[104:105], v2 offset:1928
    ds_read_b64_tr_b16 v[106:107], v2 offset:1920
    ds_read_b128 v[80:83], v5 offset:1024
    ds_read_b128 v[84:87], v5 offset:1536
    s_waitcnt lgkmcnt(8)
    v_mfma_f32_16x16x32_bf16 v[12:15], v[108:111], v[40:43], v[12:15]
    v_mfma_f32_16x16x32_bf16 v[16:19], v[108:111], v[44:47], v[16:19]
    v_mfma_f32_16x16x32_bf16 v[20:23], v[108:111], v[48:51], v[20:23]
    v_mfma_f32_16x16x32_bf16 v[24:27], v[108:111], v[52:55], v[24:27]
    v_mfma_f32_16x16x32_bf16 v[28:31], v[108:111], v[56:59], v[28:31]
    v_mfma_f32_16x16x32_bf16 v[32:35], v[108:111], v[60:63], v[32:35]
    v_mfma_f32_16x16x32_bf16 v[36:39], v[108:111], v[64:67], v[36:39]
    ds_read_b64_tr_b16 v[108:109], v2 offset:2440
    ds_read_b64_tr_b16 v[110:111], v2 offset:2432
    ds_read_b128 v[88:91], v5 offset:2048
    ds_read_b128 v[92:95], v5 offset:2560
    s_waitcnt lgkmcnt(10)
    v_mfma_f32_16x16x32_bf16 v[16:19], v[112:115], v[40:43], v[16:19]
    v_mfma_f32_16x16x32_bf16 v[20:23], v[112:115], v[44:47], v[20:23]
    v_mfma_f32_16x16x32_bf16 v[24:27], v[112:115], v[48:51], v[24:27]
    v_mfma_f32_16x16x32_bf16 v[28:31], v[112:115], v[52:55], v[28:31]
    v_mfma_f32_16x16x32_bf16 v[32:35], v[112:115], v[56:59], v[32:35]
    v_mfma_f32_16x16x32_bf16 v[36:39], v[112:115], v[60:63], v[36:39]
    ds_read_b64_tr_b16 v[112:113], v2 offset:2952
    ds_read_b64_tr_b16 v[114:115], v2 offset:2944
    ds_read_b128 v[96:99], v5 offset:3072
    ds_read_b128 v[100:103], v5 offset:3584
    s_waitcnt lgkmcnt(10)
    v_mfma_f32_16x16x32_bf16 v[20:23], v[104:107], v[40:43], v[20:23]
    v_mfma_f32_16x16x32_bf16 v[24:27], v[104:107], v[44:47], v[24:27]
    v_mfma_f32_16x16x32_bf16 v[28:31], v[104:107], v[48:51], v[28:31]
    v_mfma_f32_16x16x32_bf16 v[32:35], v[104:107], v[52:55], v[32:35]
    v_mfma_f32_16x16x32_bf16 v[36:39], v[104:107], v[56:59], v[36:39]
    ds_read_b64_tr_b16 v[104:105], v2 offset:3464
    ds_read_b64_tr_b16 v[106:107], v2 offset:3456
    s_waitcnt lgkmcnt(8)
    v_mfma_f32_16x16x32_bf16 v[24:27], v[108:111], v[40:43], v[24:27]
    v_mfma_f32_16x16x32_bf16 v[28:31], v[108:111], v[44:47], v[28:31]
    v_mfma_f32_16x16x32_bf16 v[32:35], v[108:111], v[48:51], v[32:35]
    v_mfma_f32_16x16x32_bf16 v[36:39], v[108:111], v[52:55], v[36:39]
    ds_read_b64_tr_b16 v[108:109], v2 offset:3976
    ds_read_b64_tr_b16 v[110:111], v2 offset:3968
    s_waitcnt lgkmcnt(6)
    v_mfma_f32_16x16x32_bf16 v[28:31], v[112:115], v[40:43], v[28:31]
    v_mfma_f32_16x16x32_bf16 v[32:35], v[112:115], v[44:47], v[32:35]
    v_mfma_f32_16x16x32_bf16 v[36:39], v[112:115], v[48:51], v[36:39]
    ds_read_b64_tr_b16 v[112:113], v2 offset:456
    ds_read_b64_tr_b16 v[114:115], v2 offset:448
    s_waitcnt lgkmcnt(4)
    v_mfma_f32_16x16x32_bf16 v[32:35], v[104:107], v[40:43], v[32:35]
    v_mfma_f32_16x16x32_bf16 v[36:39], v[104:107], v[44:47], v[36:39]
    ds_read_b64_tr_b16 v[104:105], v2 offset:968
    ds_read_b64_tr_b16 v[106:107], v2 offset:960
    s_waitcnt lgkmcnt(4)
    v_mfma_f32_16x16x32_bf16 v[36:39], v[108:111], v[40:43], v[36:39]
    ds_read_b64_tr_b16 v[108:109], v2 offset:1480
    ds_read_b64_tr_b16 v[110:111], v2 offset:1472
    s_waitcnt lgkmcnt(4)
    v_mfma_f32_16x16x32_bf16 v[8:11], v[112:115], v[72:75], v[8:11]
    v_mfma_f32_16x16x32_bf16 v[12:15], v[112:115], v[76:79], v[12:15]
    v_mfma_f32_16x16x32_bf16 v[16:19], v[112:115], v[80:83], v[16:19]
    v_mfma_f32_16x16x32_bf16 v[20:23], v[112:115], v[84:87], v[20:23]
    v_mfma_f32_16x16x32_bf16 v[24:27], v[112:115], v[88:91], v[24:27]
    v_mfma_f32_16x16x32_bf16 v[28:31], v[112:115], v[92:95], v[28:31]
    v_mfma_f32_16x16x32_bf16 v[32:35], v[112:115], v[96:99], v[32:35]
    v_mfma_f32_16x16x32_bf16 v[36:39], v[112:115], v[100:103], v[36:39]
    ds_read_b64_tr_b16 v[112:113], v2 offset:1992
    ds_read_b64_tr_b16 v[114:115], v2 offset:1984
    s_waitcnt lgkmcnt(4)
    v_mfma_f32_16x16x32_bf16 v[12:15], v[104:107], v[72:75], v[12:15]
    v_mfma_f32_16x16x32_bf16 v[16:19], v[104:107], v[76:79], v[16:19]
    v_mfma_f32_16x16x32_bf16 v[20:23], v[104:107], v[80:83], v[20:23]
    v_mfma_f32_16x16x32_bf16 v[24:27], v[104:107], v[84:87], v[24:27]
    v_mfma_f32_16x16x32_bf16 v[28:31], v[104:107], v[88:91], v[28:31]
    v_mfma_f32_16x16x32_bf16 v[32:35], v[104:107], v[92:95], v[32:35]
    v_mfma_f32_16x16x32_bf16 v[36:39], v[104:107], v[96:99], v[36:39]
    ds_read_b64_tr_b16 v[104:105], v2 offset:2504
    ds_read_b64_tr_b16 v[106:107], v2 offset:2496
    s_waitcnt lgkmcnt(4)
    v_mfma_f32_16x16x32_bf16 v[16:19], v[108:111], v[72:75], v[16:19]
    v_mfma_f32_16x16x32_bf16 v[20:23], v[108:111], v[76:79], v[20:23]
    v_mfma_f32_16x16x32_bf16 v[24:27], v[108:111], v[80:83], v[24:27]
    v_mfma_f32_16x16x32_bf16 v[28:31], v[108:111], v[84:87], v[28:31]
    v_mfma_f32_16x16x32_bf16 v[32:35], v[108:111], v[88:91], v[32:35]
    v_mfma_f32_16x16x32_bf16 v[36:39], v[108:111], v[92:95], v[36:39]
    ds_read_b64_tr_b16 v[108:109], v2 offset:3016
    ds_read_b64_tr_b16 v[110:111], v2 offset:3008
    s_waitcnt lgkmcnt(4)
    v_mfma_f32_16x16x32_bf16 v[20:23], v[112:115], v[72:75], v[20:23]
    v_mfma_f32_16x16x32_bf16 v[24:27], v[112:115], v[76:79], v[24:27]
    v_mfma_f32_16x16x32_bf16 v[28:31], v[112:115], v[80:83], v[28:31]
    v_mfma_f32_16x16x32_bf16 v[32:35], v[112:115], v[84:87], v[32:35]
    v_mfma_f32_16x16x32_bf16 v[36:39], v[112:115], v[88:91], v[36:39]
    ds_read_b64_tr_b16 v[112:113], v2 offset:3528
    ds_read_b64_tr_b16 v[114:115], v2 offset:3520
    s_waitcnt lgkmcnt(4)
    v_mfma_f32_16x16x32_bf16 v[24:27], v[104:107], v[72:75], v[24:27]
    v_mfma_f32_16x16x32_bf16 v[28:31], v[104:107], v[76:79], v[28:31]
    v_mfma_f32_16x16x32_bf16 v[32:35], v[104:107], v[80:83], v[32:35]
    v_mfma_f32_16x16x32_bf16 v[36:39], v[104:107], v[84:87], v[36:39]
    ds_read_b64_tr_b16 v[104:105], v2 offset:4040
    ds_read_b64_tr_b16 v[106:107], v2 offset:4032
    s_waitcnt lgkmcnt(4)
    v_mfma_f32_16x16x32_bf16 v[28:31], v[108:111], v[72:75], v[28:31]
    v_mfma_f32_16x16x32_bf16 v[32:35], v[108:111], v[76:79], v[32:35]
    v_mfma_f32_16x16x32_bf16 v[36:39], v[108:111], v[80:83], v[36:39]
    s_waitcnt lgkmcnt(2)
    v_mfma_f32_16x16x32_bf16 v[32:35], v[112:115], v[72:75], v[32:35]
    v_mfma_f32_16x16x32_bf16 v[36:39], v[112:115], v[76:79], v[36:39]
    s_waitcnt lgkmcnt(0)
    v_mfma_f32_16x16x32_bf16 v[36:39], v[104:107], v[72:75], v[36:39]
    s_waitcnt lgkmcnt(0)
    s_and_b32 s48, s53, 1
    s_lshl_b32 s48, s48, 4
    s_lshr_b32 s38, s38, s48
    s_lshl_b32 s38, s38, 16
    v_lshlrev_b32 v6, 5, v4
    v_lshl_add_u32 v6, v3, 3, v6
    s_add_u32 s47, s46, 512
    v_add_u32 v6, s47, v6
    ds_read_b64 v[40:41], v6 offset:0
    ds_read_b64 v[42:43], v6 offset:512
    ds_read_b64 v[44:45], v6 offset:1024
    ds_read_b64 v[46:47], v6 offset:1536
    ds_read_b64 v[48:49], v6 offset:2048
    ds_read_b64 v[50:51], v6 offset:2560
    ds_read_b64 v[52:53], v6 offset:3072
    ds_read_b64 v[54:55], v6 offset:3584
    s_waitcnt lgkmcnt(0)
    v_lshlrev_b32 v72, 16, v40
    v_and_b32 v73, s39, v40
    v_lshlrev_b32 v74, 16, v41
    v_and_b32 v75, s39, v41
    v_lshlrev_b32 v76, 16, v42
    v_and_b32 v77, s39, v42
    v_lshlrev_b32 v78, 16, v43
    v_and_b32 v79, s39, v43
    v_lshlrev_b32 v80, 16, v44
    v_and_b32 v81, s39, v44
    v_lshlrev_b32 v82, 16, v45
    v_and_b32 v83, s39, v45
    v_lshlrev_b32 v84, 16, v46
    v_and_b32 v85, s39, v46
    v_lshlrev_b32 v86, 16, v47
    v_and_b32 v87, s39, v47
    v_lshlrev_b32 v88, 16, v48
    v_and_b32 v89, s39, v48
    v_lshlrev_b32 v90, 16, v49
    v_and_b32 v91, s39, v49
    v_lshlrev_b32 v92, 16, v50
    v_and_b32 v93, s39, v50
    v_lshlrev_b32 v94, 16, v51
    v_and_b32 v95, s39, v51
    v_lshlrev_b32 v96, 16, v52
    v_and_b32 v97, s39, v52
    v_lshlrev_b32 v98, 16, v53
    v_and_b32 v99, s39, v53
    v_lshlrev_b32 v100, 16, v54
    v_and_b32 v101, s39, v54
    v_lshlrev_b32 v102, 16, v55
    v_and_b32 v103, s39, v55
    v_fmac_f32 v8, s38, v72
    v_fmac_f32 v9, s38, v73
    v_fmac_f32 v10, s38, v74
    v_fmac_f32 v11, s38, v75
    v_fmac_f32 v12, s38, v76
    v_fmac_f32 v13, s38, v77
    v_fmac_f32 v14, s38, v78
    v_fmac_f32 v15, s38, v79
    v_fmac_f32 v16, s38, v80
    v_fmac_f32 v17, s38, v81
    v_fmac_f32 v18, s38, v82
    v_fmac_f32 v19, s38, v83
    v_fmac_f32 v20, s38, v84
    v_fmac_f32 v21, s38, v85
    v_fmac_f32 v22, s38, v86
    v_fmac_f32 v23, s38, v87
    v_fmac_f32 v24, s38, v88
    v_fmac_f32 v25, s38, v89
    v_fmac_f32 v26, s38, v90
    v_fmac_f32 v27, s38, v91
    v_fmac_f32 v28, s38, v92
    v_fmac_f32 v29, s38, v93
    v_fmac_f32 v30, s38, v94
    v_fmac_f32 v31, s38, v95
    v_fmac_f32 v32, s38, v96
    v_fmac_f32 v33, s38, v97
    v_fmac_f32 v34, s38, v98
    v_fmac_f32 v35, s38, v99
    v_fmac_f32 v36, s38, v100
    v_fmac_f32 v37, s38, v101
    v_fmac_f32 v38, s38, v102
    v_fmac_f32 v39, s38, v103
    v_cvt_pk_bf16_f32 v40, v8, v9
    v_cvt_pk_bf16_f32 v41, v10, v11
    v_cvt_pk_bf16_f32 v42, v12, v13
    v_cvt_pk_bf16_f32 v43, v14, v15
    v_cvt_pk_bf16_f32 v44, v16, v17
    v_cvt_pk_bf16_f32 v45, v18, v19
    v_cvt_pk_bf16_f32 v46, v20, v21
    v_cvt_pk_bf16_f32 v47, v22, v23
    v_cvt_pk_bf16_f32 v48, v24, v25
    v_cvt_pk_bf16_f32 v49, v26, v27
    v_cvt_pk_bf16_f32 v50, v28, v29
    v_cvt_pk_bf16_f32 v51, v30, v31
    v_cvt_pk_bf16_f32 v52, v32, v33
    v_cvt_pk_bf16_f32 v53, v34, v35
    v_cvt_pk_bf16_f32 v54, v36, v37
    v_cvt_pk_bf16_f32 v55, v38, v39
    ds_write_b64 v6, v[40:41] offset:0
    ds_write_b64 v6, v[42:43] offset:512
    ds_write_b64 v6, v[44:45] offset:1024
    ds_write_b64 v6, v[46:47] offset:1536
    ds_write_b64 v6, v[48:49] offset:2048
    ds_write_b64 v6, v[50:51] offset:2560
    ds_write_b64 v6, v[52:53] offset:3072
    ds_write_b64 v6, v[54:55] offset:3584
    s_branch Ljoin16
Lprep15:
    s_cmp_lt_u32 s33, 4
    s_cbranch_scc1 Lnw22
    s_load_dwordx2 s[12:13], s[0:1], 56
    s_load_dwordx2 s[16:17], s[0:1], 72
    s_mov_b32 s14, 6291456
    s_mov_b32 s18, 2097152
    s_lshl_b32 s54, s34, 5
    s_add_u32 s54, s54, s35
    s_lshl_b32 s54, s54, 2
    s_add_u32 s54, s54, s51
    s_waitcnt lgkmcnt(0)
    s_cmp_ge_u32 s54, 768
    s_cbranch_scc1 Lwo23
    s_mul_i32 s55, s54, 43691
    s_lshr_b32 s55, s55, 18
    s_mul_i32 s56, s55, 6
    s_sub_u32 s56, s54, s56
    s_mul_i32 s57, s55, 49152
    s_lshl_b32 s58, s56, 10
    s_add_u32 s57, s57, s58
    v_lshl_add_u32 v3, v1, 4, s57
    s_mov_b32 s59, 0
    buffer_load_dwordx4 v[168:171], v3, s[12:15], s59 offen nt
    s_mov_b32 s59, 6144
    buffer_load_dwordx4 v[172:175], v3, s[12:15], s59 offen nt
    s_mov_b32 s59, 12288
    buffer_load_dwordx4 v[176:179], v3, s[12:15], s59 offen nt
    s_mov_b32 s59, 18432
    buffer_load_dwordx4 v[180:183], v3, s[12:15], s59 offen nt
    s_mov_b32 s59, 24576
    buffer_load_dwordx4 v[184:187], v3, s[12:15], s59 offen nt
    s_mov_b32 s59, 30720
    buffer_load_dwordx4 v[188:191], v3, s[12:15], s59 offen nt
    s_mov_b32 s59, 36864
    buffer_load_dwordx4 v[192:195], v3, s[12:15], s59 offen nt
    s_mov_b32 s59, 43008
    buffer_load_dwordx4 v[196:199], v3, s[12:15], s59 offen nt
    s_branch Lnw22
Lwo23:
    s_sub_u32 s57, s54, 768
    s_lshr_b32 s55, s57, 1
    s_and_b32 s56, s57, 1
    s_mul_i32 s57, s55, 16384
    s_lshl_b32 s58, s56, 10
    s_add_u32 s57, s57, s58
    v_lshl_add_u32 v3, v1, 4, s57
    s_mov_b32 s59, 0
    buffer_load_dwordx4 v[168:171], v3, s[16:19], s59 offen nt
    s_mov_b32 s59, 2048
    buffer_load_dwordx4 v[172:175], v3, s[16:19], s59 offen nt
    s_mov_b32 s59, 4096
    buffer_load_dwordx4 v[176:179], v3, s[16:19], s59 offen nt
    s_mov_b32 s59, 6144
    buffer_load_dwordx4 v[180:183], v3, s[16:19], s59 offen nt
    s_mov_b32 s59, 8192
    buffer_load_dwordx4 v[184:187], v3, s[16:19], s59 offen nt
    s_mov_b32 s59, 10240
    buffer_load_dwordx4 v[188:191], v3, s[16:19], s59 offen nt
    s_mov_b32 s59, 12288
    buffer_load_dwordx4 v[192:195], v3, s[16:19], s59 offen nt
    s_mov_b32 s59, 14336
    buffer_load_dwordx4 v[196:199], v3, s[16:19], s59 offen nt
Lnw22:
    s_cmp_ge_u32 s54, 768
    s_cbranch_scc1 Lwo225
    s_mov_b32 s60, 0x05040100
    s_mov_b32 s61, 0x07060302
    s_waitcnt vmcnt(0)
    v_perm_b32 v40, v172, v168, s60
    v_perm_b32 v41, v180, v176, s60
    v_perm_b32 v42, v188, v184, s60
    v_perm_b32 v43, v196, v192, s60
    v_perm_b32 v44, v172, v168, s61
    v_perm_b32 v45, v180, v176, s61
    v_perm_b32 v46, v188, v184, s61
    v_perm_b32 v47, v196, v192, s61
    v_perm_b32 v48, v173, v169, s60
    v_perm_b32 v49, v181, v177, s60
    v_perm_b32 v50, v189, v185, s60
    v_perm_b32 v51, v197, v193, s60
    v_perm_b32 v52, v173, v169, s61
    v_perm_b32 v53, v181, v177, s61
    v_perm_b32 v54, v189, v185, s61
    v_perm_b32 v55, v197, v193, s61
    v_perm_b32 v56, v174, v170, s60
    v_perm_b32 v57, v182, v178, s60
    v_perm_b32 v58, v190, v186, s60
    v_perm_b32 v59, v198, v194, s60
    v_perm_b32 v60, v174, v170, s61
    v_perm_b32 v61, v182, v178, s61
    v_perm_b32 v62, v190, v186, s61
    v_perm_b32 v63, v198, v194, s61
    v_perm_b32 v64, v175, v171, s60
    v_perm_b32 v65, v183, v179, s60
    v_perm_b32 v66, v191, v187, s60
    v_perm_b32 v67, v199, v195, s60
    v_perm_b32 v68, v175, v171, s61
    v_perm_b32 v69, v183, v179, s61
    v_perm_b32 v70, v191, v187, s61
    v_perm_b32 v71, v199, v195, s61
    s_lshl_b32 s42, s51, 13
    s_add_u32 s42, s42, 84992
    v_and_b32 v5, 7, v1
    v_lshlrev_b32 v6, 7, v1
    v_add_u32 v6, s42, v6
    v_xor_b32 v7, 0, v5
    v_lshl_add_u32 v7, v7, 4, v6
    ds_write_b128 v7, v[40:43]
    v_xor_b32 v7, 1, v5
    v_lshl_add_u32 v7, v7, 4, v6
    ds_write_b128 v7, v[44:47]
    v_xor_b32 v7, 2, v5
    v_lshl_add_u32 v7, v7, 4, v6
    ds_write_b128 v7, v[48:51]
    v_xor_b32 v7, 3, v5
    v_lshl_add_u32 v7, v7, 4, v6
    ds_write_b128 v7, v[52:55]
    v_xor_b32 v7, 4, v5
    v_lshl_add_u32 v7, v7, 4, v6
    ds_write_b128 v7, v[56:59]
    v_xor_b32 v7, 5, v5
    v_lshl_add_u32 v7, v7, 4, v6
    ds_write_b128 v7, v[60:63]
    v_xor_b32 v7, 6, v5
    v_lshl_add_u32 v7, v7, 4, v6
    ds_write_b128 v7, v[64:67]
    v_xor_b32 v7, 7, v5
    v_lshl_add_u32 v7, v7, 4, v6
    ds_write_b128 v7, v[68:71]
    v_lshrrev_b32 v5, 5, v1
    v_bfe_u32 v6, v1, 3, 2
    v_lshl_add_u32 v5, v5, 2, v6
    v_and_b32 v6, 7, v1
    v_xor_b32 v6, v6, v5
    v_and_b32 v6, 7, v6
    v_lshlrev_b32 v6, 4, v6
    v_lshl_add_u32 v6, v5, 7, v6
    v_add_u32 v6, s42, v6
    s_waitcnt lgkmcnt(0)
    ds_read_b128 v[8:11], v6 offset:0
    ds_read_b128 v[12:15], v6 offset:1024
    ds_read_b128 v[16:19], v6 offset:2048
    ds_read_b128 v[20:23], v6 offset:3072
    ds_read_b128 v[24:27], v6 offset:4096
    ds_read_b128 v[28:31], v6 offset:5120
    ds_read_b128 v[32:35], v6 offset:6144
    ds_read_b128 v[36:39], v6 offset:7168
    s_and_b32 s60, s56, 1
    s_lshl_b32 s60, s60, 4
    v_lshrrev_b32 v4, 5, v1
    v_add_u32 v4, s60, v4
    s_mov_b32 s61, 196608
    v_mul_lo_u32 v4, s61, v4
    s_lshr_b32 s62, s55, 1
    s_mul_i32 s62, s62, 3072
    s_lshr_b32 s63, s56, 1
    s_lshl_b32 s63, s63, 10
    s_add_u32 s62, s62, s63
    s_and_b32 s63, s55, 1
    s_lshl_b32 s63, s63, 9
    s_add_u32 s62, s62, s63
    s_add_u32 s62, s62, 12582912
    v_and_b32 v5, 31, v1
    v_lshl_add_u32 v4, v5, 4, v4
    v_add_u32 v4, s62, v4
    s_waitcnt lgkmcnt(0)
    s_mov_b32 s42, 0
    buffer_store_dwordx4 v[8:11], v4, s[8:11], s42 offen sc1
    s_mov_b32 s42, 393216
    buffer_store_dwordx4 v[12:15], v4, s[8:11], s42 offen sc1
    s_mov_b32 s42, 786432
    buffer_store_dwordx4 v[16:19], v4, s[8:11], s42 offen sc1
    s_mov_b32 s42, 1179648
    buffer_store_dwordx4 v[20:23], v4, s[8:11], s42 offen sc1
    s_mov_b32 s42, 1572864
    buffer_store_dwordx4 v[24:27], v4, s[8:11], s42 offen sc1
    s_mov_b32 s42, 1966080
    buffer_store_dwordx4 v[28:31], v4, s[8:11], s42 offen sc1
    s_mov_b32 s42, 2359296
    buffer_store_dwordx4 v[32:35], v4, s[8:11], s42 offen sc1
    s_mov_b32 s42, 2752512
    buffer_store_dwordx4 v[36:39], v4, s[8:11], s42 offen sc1
    s_branch Let26
Lwo225:
    s_mov_b32 s60, 0x05040100
    s_mov_b32 s61, 0x07060302
    s_waitcnt vmcnt(0)
    v_perm_b32 v40, v172, v168, s60
    v_perm_b32 v41, v180, v176, s60
    v_perm_b32 v42, v188, v184, s60
    v_perm_b32 v43, v196, v192, s60
    v_perm_b32 v44, v172, v168, s61
    v_perm_b32 v45, v180, v176, s61
    v_perm_b32 v46, v188, v184, s61
    v_perm_b32 v47, v196, v192, s61
    v_perm_b32 v48, v173, v169, s60
    v_perm_b32 v49, v181, v177, s60
    v_perm_b32 v50, v189, v185, s60
    v_perm_b32 v51, v197, v193, s60
    v_perm_b32 v52, v173, v169, s61
    v_perm_b32 v53, v181, v177, s61
    v_perm_b32 v54, v189, v185, s61
    v_perm_b32 v55, v197, v193, s61
    v_perm_b32 v56, v174, v170, s60
    v_perm_b32 v57, v182, v178, s60
    v_perm_b32 v58, v190, v186, s60
    v_perm_b32 v59, v198, v194, s60
    v_perm_b32 v60, v174, v170, s61
    v_perm_b32 v61, v182, v178, s61
    v_perm_b32 v62, v190, v186, s61
    v_perm_b32 v63, v198, v194, s61
    v_perm_b32 v64, v175, v171, s60
    v_perm_b32 v65, v183, v179, s60
    v_perm_b32 v66, v191, v187, s60
    v_perm_b32 v67, v199, v195, s60
    v_perm_b32 v68, v175, v171, s61
    v_perm_b32 v69, v183, v179, s61
    v_perm_b32 v70, v191, v187, s61
    v_perm_b32 v71, v199, v195, s61
    s_lshl_b32 s42, s51, 13
    s_add_u32 s42, s42, 84992
    v_and_b32 v5, 7, v1
    v_lshlrev_b32 v6, 7, v1
    v_add_u32 v6, s42, v6
    v_xor_b32 v7, 0, v5
    v_lshl_add_u32 v7, v7, 4, v6
    ds_write_b128 v7, v[40:43]
    v_xor_b32 v7, 1, v5
    v_lshl_add_u32 v7, v7, 4, v6
    ds_write_b128 v7, v[44:47]
    v_xor_b32 v7, 2, v5
    v_lshl_add_u32 v7, v7, 4, v6
    ds_write_b128 v7, v[48:51]
    v_xor_b32 v7, 3, v5
    v_lshl_add_u32 v7, v7, 4, v6
    ds_write_b128 v7, v[52:55]
    v_xor_b32 v7, 4, v5
    v_lshl_add_u32 v7, v7, 4, v6
    ds_write_b128 v7, v[56:59]
    v_xor_b32 v7, 5, v5
    v_lshl_add_u32 v7, v7, 4, v6
    ds_write_b128 v7, v[60:63]
    v_xor_b32 v7, 6, v5
    v_lshl_add_u32 v7, v7, 4, v6
    ds_write_b128 v7, v[64:67]
    v_xor_b32 v7, 7, v5
    v_lshl_add_u32 v7, v7, 4, v6
    ds_write_b128 v7, v[68:71]
    v_lshrrev_b32 v5, 5, v1
    v_bfe_u32 v6, v1, 3, 2
    v_lshl_add_u32 v5, v5, 2, v6
    v_and_b32 v6, 7, v1
    v_xor_b32 v6, v6, v5
    v_and_b32 v6, 7, v6
    v_lshlrev_b32 v6, 4, v6
    v_lshl_add_u32 v6, v5, 7, v6
    v_add_u32 v6, s42, v6
    s_waitcnt lgkmcnt(0)
    ds_read_b128 v[8:11], v6 offset:0
    ds_read_b128 v[12:15], v6 offset:1024
    ds_read_b128 v[16:19], v6 offset:2048
    ds_read_b128 v[20:23], v6 offset:3072
    ds_read_b128 v[24:27], v6 offset:4096
    ds_read_b128 v[28:31], v6 offset:5120
    ds_read_b128 v[32:35], v6 offset:6144
    ds_read_b128 v[36:39], v6 offset:7168
    s_lshl_b32 s60, s56, 20
    v_lshrrev_b32 v4, 5, v1
    v_lshlrev_b32 v4, 10, v4
    s_lshr_b32 s62, s55, 1
    s_lshl_b32 s62, s62, 11
    s_and_b32 s63, s55, 1
    s_lshl_b32 s63, s63, 9
    s_add_u32 s62, s62, s63
    s_add_u32 s62, s62, s60
    s_add_u32 s62, s62, 18874368
    v_and_b32 v5, 31, v1
    v_lshl_add_u32 v4, v5, 4, v4
    v_add_u32 v4, s62, v4
    s_waitcnt lgkmcnt(0)
    s_mov_b32 s42, 0
    buffer_store_dwordx4 v[8:11], v4, s[8:11], s42 offen sc1
    s_mov_b32 s42, 131072
    buffer_store_dwordx4 v[12:15], v4, s[8:11], s42 offen sc1
    s_mov_b32 s42, 262144
    buffer_store_dwordx4 v[16:19], v4, s[8:11], s42 offen sc1
    s_mov_b32 s42, 393216
    buffer_store_dwordx4 v[20:23], v4, s[8:11], s42 offen sc1
    s_mov_b32 s42, 524288
    buffer_store_dwordx4 v[24:27], v4, s[8:11], s42 offen sc1
    s_mov_b32 s42, 655360
    buffer_store_dwordx4 v[28:31], v4, s[8:11], s42 offen sc1
    s_mov_b32 s42, 786432
    buffer_store_dwordx4 v[32:35], v4, s[8:11], s42 offen sc1
    s_mov_b32 s42, 917504
    buffer_store_dwordx4 v[36:39], v4, s[8:11], s42 offen sc1
Let26:
Ljoin16:
    s_waitcnt lgkmcnt(0)
    s_barrier
    v_lshlrev_b32 v6, 2, v0
    v_add_u32 v6, 67072, v6
    ds_read_b32 v8, v6 offset:0
    ds_read_b32 v9, v6 offset:4608
    ds_read_b32 v10, v6 offset:9216
    ds_read_b32 v11, v6 offset:13824
    ds_read_b32 v12, v6 offset:2048
    ds_read_b32 v13, v6 offset:6656
    ds_read_b32 v14, v6 offset:11264
    ds_read_b32 v15, v6 offset:15872
    s_mov_b32 s60, 0x05040100
    s_mov_b32 s61, 0x07060302
    s_lshl_b32 s54, s34, 5
    s_add_u32 s54, s54, s35
    s_mul_i32 s54, s54, 16512
    s_add_u32 s54, s54, 7340032
    v_lshl_add_u32 v7, v0, 4, s54
    s_mov_b32 s55, 8192
    s_waitcnt lgkmcnt(0)
    v_perm_b32 v16, v9, v8, s60
    v_perm_b32 v17, v11, v10, s60
    v_perm_b32 v18, v9, v8, s61
    v_perm_b32 v19, v11, v10, s61
    v_perm_b32 v20, v13, v12, s60
    v_perm_b32 v21, v15, v14, s60
    v_perm_b32 v22, v13, v12, s61
    v_perm_b32 v23, v15, v14, s61
    buffer_store_dwordx4 v[16:19], v7, s[8:11], 0 offen sc1
    buffer_store_dwordx4 v[20:23], v7, s[8:11], s55 offen sc1
    s_waitcnt vmcnt(0)
    s_barrier
    s_cmp_lg_u32 s33, 0
    s_cbranch_scc1 Lpb27
    s_lshl_b32 s42, s34, 8
    s_lshl_b32 s43, s35, 3
    s_add_u32 s42, s42, s43
    s_add_u32 s42, s42, 48236544
    v_mov_b32 v230, s42
    v_mov_b32 v232, s6
    v_mov_b32 v233, s7
    s_mov_b64 exec, 1
    buffer_store_dwordx2 v[232:233], v230, s[8:11], 0 offen sc1
    s_mov_b64 exec, -1
Lpb27:
    v_and_b32 v1, 7, v0
    v_lshrrev_b32 v2, 3, v0
    s_lshl_b32 s42, s34, 8
    s_lshl_b32 s43, s35, 3
    s_add_u32 s42, s42, s43
    v_add_u32 v3, s42, v1
    v_lshrrev_b32 v4, 6, v0
    v_mul_u32_u24 v5, 6144, v2
    v_lshl_add_u32 v5, v1, 4, v5
    s_mul_i32 s44, s34, 786432
    s_lshl_b32 s45, s35, 7
    s_add_u32 s44, s44, s45
    v_add_u32 v5, s44, v5
    v_mul_u32_u24 v7, 33024, v2
    v_lshl_add_u32 v7, v3, 3, v7
    v_lshlrev_b32 v96, 6, v1
    v_add_u32 v96, 161792, v96
    v_lshl_add_u32 v97, v4, 3, v96
    s_mul_i32 s56, s35, 196608
    s_mul_i32 s57, s33, 3072
    s_add_u32 s56, s56, s57
    v_and_b32 v236, 63, v0
    v_lshl_add_u32 v236, v236, 4, s56
    s_load_dwordx2 s[16:17], s[0:1], 64
    s_mov_b32 s18, 65536
    v_and_b32 v121, 63, v0
    v_lshrrev_b32 v122, 5, v121
    v_and_b32 v121, 31, v121
    s_lshl_b32 s46, s35, 11
    v_lshlrev_b32 v120, 8, v122
    v_lshl_add_u32 v120, v121, 1, v120
    v_add_u32 v120, s46, v120
    s_waitcnt lgkmcnt(0)
    buffer_load_ushort v200, v120, s[16:19], 0 offen offset:0
    buffer_load_ushort v201, v120, s[16:19], 0 offen offset:64
    buffer_load_ushort v202, v120, s[16:19], 0 offen offset:128
    buffer_load_ushort v203, v120, s[16:19], 0 offen offset:192
    buffer_load_ushort v204, v120, s[16:19], 0 offen offset:512
    buffer_load_ushort v205, v120, s[16:19], 0 offen offset:576
    buffer_load_ushort v206, v120, s[16:19], 0 offen offset:640
    buffer_load_ushort v207, v120, s[16:19], 0 offen offset:704
    buffer_load_ushort v208, v120, s[16:19], 0 offen offset:1024
    buffer_load_ushort v209, v120, s[16:19], 0 offen offset:1088
    buffer_load_ushort v210, v120, s[16:19], 0 offen offset:1152
    buffer_load_ushort v211, v120, s[16:19], 0 offen offset:1216
    buffer_load_ushort v212, v120, s[16:19], 0 offen offset:1536
    buffer_load_ushort v213, v120, s[16:19], 0 offen offset:1600
    buffer_load_ushort v214, v120, s[16:19], 0 offen offset:1664
    buffer_load_ushort v215, v120, s[16:19], 0 offen offset:1728
    v_lshlrev_b32 v24, 16, v160
    v_and_b32 v25, s39, v160
    v_lshlrev_b32 v26, 16, v161
    v_and_b32 v27, s39, v161
    v_lshlrev_b32 v28, 16, v162
    v_and_b32 v29, s39, v162
    v_lshlrev_b32 v30, 16, v163
    v_and_b32 v31, s39, v163
    v_lshlrev_b32 v32, 16, v164
    v_and_b32 v33, s39, v164
    v_lshlrev_b32 v34, 16, v165
    v_and_b32 v35, s39, v165
    v_lshlrev_b32 v36, 16, v166
    v_and_b32 v37, s39, v166
    v_lshlrev_b32 v38, 16, v167
    v_and_b32 v39, s39, v167
    v_add_f32 v98, v24, v25
    v_add_f32 v102, v26, v27
    v_mul_f32 v99, v24, v24
    v_mul_f32 v103, v25, v25
    v_fmac_f32 v99, v26, v26
    v_fmac_f32 v103, v27, v27
    v_add_f32 v98, v98, v28
    v_add_f32 v102, v102, v29
    v_fmac_f32 v99, v28, v28
    v_fmac_f32 v103, v29, v29
    v_add_f32 v98, v98, v30
    v_add_f32 v102, v102, v31
    v_fmac_f32 v99, v30, v30
    v_fmac_f32 v103, v31, v31
    v_add_f32 v98, v98, v32
    v_add_f32 v102, v102, v33
    v_fmac_f32 v99, v32, v32
    v_fmac_f32 v103, v33, v33
    v_add_f32 v98, v98, v34
    v_add_f32 v102, v102, v35
    v_fmac_f32 v99, v34, v34
    v_fmac_f32 v103, v35, v35
    v_add_f32 v98, v98, v36
    v_add_f32 v102, v102, v37
    v_fmac_f32 v99, v36, v36
    v_fmac_f32 v103, v37, v37
    v_add_f32 v98, v98, v38
    v_add_f32 v102, v102, v39
    v_fmac_f32 v99, v38, v38
    v_fmac_f32 v103, v39, v39
    v_add_f32 v98, v98, v102
    v_add_f32 v99, v99, v103
    s_nop 0
    v_add_f32_dpp v98, v98, v98 row_ror:8 row_mask:0xf bank_mask:0xf
    v_add_f32_dpp v99, v99, v99 row_ror:8 row_mask:0xf bank_mask:0xf
    v_mov_b32 v102, v98
    v_mov_b32 v103, v99
    s_nop 0
    v_permlane16_swap_b32 v98, v102
    v_permlane16_swap_b32 v99, v103
    v_add_f32 v98, v98, v102
    v_add_f32 v99, v99, v103
    v_mov_b32 v102, v98
    v_mov_b32 v103, v99
    s_nop 0
    v_permlane32_swap_b32 v98, v102
    v_permlane32_swap_b32 v99, v103
    v_add_f32 v98, v98, v102
    v_add_f32 v99, v99, v103
    ds_write_b64 v97, v[98:99] offset:0
    s_waitcnt lgkmcnt(0)
    s_barrier
    ds_read_b128 v[104:107], v96 offset:0
    ds_read_b128 v[108:111], v96 offset:16
    ds_read_b128 v[112:115], v96 offset:32
    ds_read_b128 v[116:119], v96 offset:48
    s_waitcnt lgkmcnt(0)
    v_add_f32 v104, v104, v106
    v_add_f32 v105, v105, v107
    v_add_f32 v108, v108, v110
    v_add_f32 v109, v109, v111
    v_add_f32 v112, v112, v114
    v_add_f32 v113, v113, v115
    v_add_f32 v116, v116, v118
    v_add_f32 v117, v117, v119
    v_add_f32 v104, v104, v108
    v_add_f32 v105, v105, v109
    v_add_f32 v112, v112, v116
    v_add_f32 v113, v113, v117
    v_add_f32 v104, v104, v112
    v_add_f32 v105, v105, v113
    v_mul_f32 v104, 0x3a800000, v104
    v_mul_f32 v105, 0x3a800000, v105
    v_fma_f32 v105, -v104, v104, v105
    v_max_f32 v105, 0, v105
    v_add_f32 v105, 0x3727c5ac, v105
    v_rsq_f32 v100, v105
    v_mul_f32 v102, -1.0, v104
    v_mov_b32 v101, v100
    v_mul_f32 v102, v102, v100
    v_mov_b32 v103, v102
    v_pk_fma_f32 v[40:41], v[24:25], v[100:101], v[102:103]
    v_pk_fma_f32 v[42:43], v[26:27], v[100:101], v[102:103]
    v_pk_fma_f32 v[44:45], v[28:29], v[100:101], v[102:103]
    v_pk_fma_f32 v[46:47], v[30:31], v[100:101], v[102:103]
    v_pk_fma_f32 v[48:49], v[32:33], v[100:101], v[102:103]
    v_pk_fma_f32 v[50:51], v[34:35], v[100:101], v[102:103]
    v_pk_fma_f32 v[52:53], v[36:37], v[100:101], v[102:103]
    v_pk_fma_f32 v[54:55], v[38:39], v[100:101], v[102:103]
    s_waitcnt vmcnt(0)
    v_lshl_or_b32 v240, v201, 16, v200
    v_lshl_or_b32 v241, v203, 16, v202
    v_lshl_or_b32 v242, v205, 16, v204
    v_lshl_or_b32 v243, v207, 16, v206
    v_lshl_or_b32 v244, v209, 16, v208
    v_lshl_or_b32 v245, v211, 16, v210
    v_lshl_or_b32 v246, v213, 16, v212
    v_lshl_or_b32 v247, v215, 16, v214
    s_cmp_lg_u32 s33, 0
    s_cbranch_scc1 Lwo28
    v_and_b32 v200, 63, v0
    v_lshlrev_b32 v200, 5, v200
    s_mov_b32 s42, 48236544
    v_add_u32 v200, s42, v200
    s_mov_b32 s43, 0
Lpl31:
    buffer_load_dwordx4 v[202:205], v200, s[8:11], 0 offen sc1
    buffer_load_dwordx4 v[206:209], v200, s[8:11], 0 offen offset:16 sc1
    s_add_u32 s43, s43, 1
    s_cmp_gt_u32 s43, 500000
    s_cbranch_scc1 Lwf30
    s_waitcnt vmcnt(0)
    v_xor_b32 v202, s6, v202
    v_xor_b32 v203, s7, v203
    v_xor_b32 v204, s6, v204
    v_xor_b32 v205, s7, v205
    v_xor_b32 v206, s6, v206
    v_xor_b32 v207, s7, v207
    v_xor_b32 v208, s6, v208
    v_xor_b32 v209, s7, v209
    v_or3_b32 v202, v202, v203, v204
    v_or3_b32 v205, v205, v206, v207
    v_or3_b32 v208, v208, v209, v202
    v_or_b32 v201, v205, v208
    v_cmp_ne_u32 vcc, 0, v201
    s_cbranch_vccnz Lpl31
Lwf30:
    s_waitcnt vmcnt(0)
Lwo28:
    s_barrier
    s_mov_b32 s42, 7340032
    s_mov_b32 s43, 7356544
    s_mov_b32 s44, 9453568
    s_mov_b32 s45, 9470080
    buffer_load_dwordx2 v[16:17], v7, s[8:11], s42 offen
    buffer_load_dwordx2 v[18:19], v7, s[8:11], s43 offen
    buffer_load_dwordx2 v[20:21], v7, s[8:11], s44 offen
    buffer_load_dwordx2 v[22:23], v7, s[8:11], s45 offen
    s_or_b32 s42, s34, s35
    s_or_b32 s42, s42, s33
    s_cmp_lg_u32 s42, 0
    s_cbranch_scc1 Lnz32
    v_mov_b32 v200, 48267264
    v_mov_b32 v202, s6
    v_mov_b32 v203, s7
    s_mov_b64 exec, 1
    buffer_store_dwordx2 v[202:203], v200, s[8:11], 0 offen sc1
    s_mov_b64 exec, -1
    s_waitcnt vmcnt(0)
Lnz32:
    s_waitcnt vmcnt(0)
    v_lshlrev_b32 v64, 16, v16
    v_and_b32 v65, s39, v16
    v_lshlrev_b32 v66, 16, v17
    v_and_b32 v67, s39, v17
    v_lshlrev_b32 v68, 16, v18
    v_and_b32 v69, s39, v18
    v_lshlrev_b32 v70, 16, v19
    v_and_b32 v71, s39, v19
    v_lshlrev_b32 v72, 16, v20
    v_and_b32 v73, s39, v20
    v_lshlrev_b32 v74, 16, v21
    v_and_b32 v75, s39, v21
    v_lshlrev_b32 v76, 16, v22
    v_and_b32 v77, s39, v22
    v_lshlrev_b32 v78, 16, v23
    v_and_b32 v79, s39, v23
    v_fmac_f32 v24, v40, v64
    v_fmac_f32 v25, v41, v65
    v_fmac_f32 v26, v42, v66
    v_fmac_f32 v27, v43, v67
    v_fmac_f32 v28, v44, v68
    v_fmac_f32 v29, v45, v69
    v_fmac_f32 v30, v46, v70
    v_fmac_f32 v31, v47, v71
    v_fmac_f32 v32, v48, v72
    v_fmac_f32 v33, v49, v73
    v_fmac_f32 v34, v50, v74
    v_fmac_f32 v35, v51, v75
    v_fmac_f32 v36, v52, v76
    v_fmac_f32 v37, v53, v77
    v_fmac_f32 v38, v54, v78
    v_fmac_f32 v39, v55, v79
    v_cvt_pk_bf16_f32 v80, v24, v25
    v_cvt_pk_bf16_f32 v81, v26, v27
    v_cvt_pk_bf16_f32 v82, v28, v29
    v_cvt_pk_bf16_f32 v83, v30, v31
    v_cvt_pk_bf16_f32 v84, v32, v33
    v_cvt_pk_bf16_f32 v85, v34, v35
    v_cvt_pk_bf16_f32 v86, v36, v37
    v_cvt_pk_bf16_f32 v87, v38, v39
    s_mov_b32 s42, 28311552
    s_mov_b32 s43, 28704768
    buffer_store_dwordx4 v[80:83], v5, s[8:11], s42 offen sc1
    buffer_store_dwordx4 v[84:87], v5, s[8:11], s43 offen sc1
    v_add_f32 v98, v24, v25
    v_add_f32 v102, v26, v27
    v_mul_f32 v99, v24, v24
    v_mul_f32 v103, v25, v25
    v_fmac_f32 v99, v26, v26
    v_fmac_f32 v103, v27, v27
    v_add_f32 v98, v98, v28
    v_add_f32 v102, v102, v29
    v_fmac_f32 v99, v28, v28
    v_fmac_f32 v103, v29, v29
    v_add_f32 v98, v98, v30
    v_add_f32 v102, v102, v31
    v_fmac_f32 v99, v30, v30
    v_fmac_f32 v103, v31, v31
    v_add_f32 v98, v98, v32
    v_add_f32 v102, v102, v33
    v_fmac_f32 v99, v32, v32
    v_fmac_f32 v103, v33, v33
    v_add_f32 v98, v98, v34
    v_add_f32 v102, v102, v35
    v_fmac_f32 v99, v34, v34
    v_fmac_f32 v103, v35, v35
    v_add_f32 v98, v98, v36
    v_add_f32 v102, v102, v37
    v_fmac_f32 v99, v36, v36
    v_fmac_f32 v103, v37, v37
    v_add_f32 v98, v98, v38
    v_add_f32 v102, v102, v39
    v_fmac_f32 v99, v38, v38
    v_fmac_f32 v103, v39, v39
    v_add_f32 v98, v98, v102
    v_add_f32 v99, v99, v103
    s_nop 0
    v_add_f32_dpp v98, v98, v98 row_ror:8 row_mask:0xf bank_mask:0xf
    v_add_f32_dpp v99, v99, v99 row_ror:8 row_mask:0xf bank_mask:0xf
    v_mov_b32 v102, v98
    v_mov_b32 v103, v99
    s_nop 0
    v_permlane16_swap_b32 v98, v102
    v_permlane16_swap_b32 v99, v103
    v_add_f32 v98, v98, v102
    v_add_f32 v99, v99, v103
    v_mov_b32 v102, v98
    v_mov_b32 v103, v99
    s_nop 0
    v_permlane32_swap_b32 v98, v102
    v_permlane32_swap_b32 v99, v103
    v_add_f32 v98, v98, v102
    v_add_f32 v99, v99, v103
    ds_write_b64 v97, v[98:99] offset:512
    s_waitcnt lgkmcnt(0)
    s_barrier
    ds_read_b128 v[104:107], v96 offset:512
    ds_read_b128 v[108:111], v96 offset:528
    ds_read_b128 v[112:115], v96 offset:544
    ds_read_b128 v[116:119], v96 offset:560
    s_waitcnt lgkmcnt(0)
    v_add_f32 v104, v104, v106
    v_add_f32 v105, v105, v107
    v_add_f32 v108, v108, v110
    v_add_f32 v109, v109, v111
    v_add_f32 v112, v112, v114
    v_add_f32 v113, v113, v115
    v_add_f32 v116, v116, v118
    v_add_f32 v117, v117, v119
    v_add_f32 v104, v104, v108
    v_add_f32 v105, v105, v109
    v_add_f32 v112, v112, v116
    v_add_f32 v113, v113, v117
    v_add_f32 v104, v104, v112
    v_add_f32 v105, v105, v113
    v_mul_f32 v104, 0x3a800000, v104
    v_mul_f32 v105, 0x3a800000, v105
    v_fma_f32 v105, -v104, v104, v105
    v_max_f32 v105, 0, v105
    v_add_f32 v105, 0x3727c5ac, v105
    v_rsq_f32 v100, v105
    v_mul_f32 v102, -1.0, v104
    v_mov_b32 v101, v100
    v_mul_f32 v102, v102, v100
    v_mov_b32 v103, v102
    v_pk_fma_f32 v[40:41], v[24:25], v[100:101], v[102:103]
    v_pk_fma_f32 v[42:43], v[26:27], v[100:101], v[102:103]
    v_pk_fma_f32 v[44:45], v[28:29], v[100:101], v[102:103]
    v_pk_fma_f32 v[46:47], v[30:31], v[100:101], v[102:103]
    v_pk_fma_f32 v[48:49], v[32:33], v[100:101], v[102:103]
    v_pk_fma_f32 v[50:51], v[34:35], v[100:101], v[102:103]
    v_pk_fma_f32 v[52:53], v[36:37], v[100:101], v[102:103]
    v_pk_fma_f32 v[54:55], v[38:39], v[100:101], v[102:103]
    v_cvt_pk_bf16_f32 v56, v40, v41
    v_cvt_pk_bf16_f32 v57, v42, v43
    v_cvt_pk_bf16_f32 v58, v44, v45
    v_cvt_pk_bf16_f32 v59, v46, v47
    v_cvt_pk_bf16_f32 v60, v48, v49
    v_cvt_pk_bf16_f32 v61, v50, v51
    v_cvt_pk_bf16_f32 v62, v52, v53
    v_cvt_pk_bf16_f32 v63, v54, v55
    s_cmp_eq_u32 s36, 0
    s_cbranch_scc1 Lst33
    s_mov_b32 s42, 0
    s_mov_b32 s43, 393216
    buffer_store_dwordx4 v[56:59], v5, s[8:11], s42 offen
    buffer_store_dwordx4 v[60:63], v5, s[8:11], s43 offen
    s_branch Lsd34
Lst33:
    s_mov_b32 s42, 0
    s_mov_b32 s43, 393216
    buffer_store_dwordx4 v[56:59], v5, s[8:11], s42 offen sc1
    buffer_store_dwordx4 v[60:63], v5, s[8:11], s43 offen sc1
Lsd34:
    s_waitcnt vmcnt(0)
    s_barrier
    s_cmp_lg_u32 s33, 0
    s_cbranch_scc1 Lpb35
    s_lshl_b32 s42, s34, 8
    s_lshl_b32 s43, s35, 3
    s_add_u32 s42, s42, s43
    s_add_u32 s42, s42, 48238592
    v_mov_b32 v230, s42
    v_mov_b32 v232, s6
    v_mov_b32 v233, s7
    s_mov_b64 exec, 1
    s_cmp_eq_u32 s36, 0
    s_cbranch_scc1 Lst36
    buffer_store_dwordx2 v[232:233], v230, s[8:11], 0 offen
    s_branch Lsd37
Lst36:
    buffer_store_dwordx2 v[232:233], v230, s[8:11], 0 offen sc1
Lsd37:
    s_mov_b64 exec, -1
Lpb35:
Llayer3:
    v_and_b32 v1, 63, v0
    v_and_b32 v5, 31, v1
    v_lshrrev_b32 v6, 5, v1
    s_mul_i32 s42, s34, 786432
    s_lshl_b32 s43, s33, 9
    s_add_u32 s42, s42, s43
    v_lshl_add_u32 v2, v5, 4, s42
    v_mul_u32_u24 v7, 6144, v6
    v_add_u32 v2, v2, v7
    v_lshlrev_b32 v3, 4, v1
    v_add_u32 v228, 49152, v3
    v_add_u32 v229, 98304, v3
    v_mov_b32 v8, 0
    v_mov_b32 v9, 0
    v_mov_b32 v10, 0
    v_mov_b32 v11, 0
    v_mov_b32 v12, 0
    v_mov_b32 v13, 0
    v_mov_b32 v14, 0
    v_mov_b32 v15, 0
    v_mov_b32 v16, 0
    v_mov_b32 v17, 0
    v_mov_b32 v18, 0
    v_mov_b32 v19, 0
    v_mov_b32 v20, 0
    v_mov_b32 v21, 0
    v_mov_b32 v22, 0
    v_mov_b32 v23, 0
    v_mov_b32 v24, 0
    v_mov_b32 v25, 0
    v_mov_b32 v26, 0
    v_mov_b32 v27, 0
    v_mov_b32 v28, 0
    v_mov_b32 v29, 0
    v_mov_b32 v30, 0
    v_mov_b32 v31, 0
    v_mov_b32 v32, 0
    v_mov_b32 v33, 0
    v_mov_b32 v34, 0
    v_mov_b32 v35, 0
    v_mov_b32 v36, 0
    v_mov_b32 v37, 0
    v_mov_b32 v38, 0
    v_mov_b32 v39, 0
    v_mov_b32 v40, 0
    v_mov_b32 v41, 0
    v_mov_b32 v42, 0
    v_mov_b32 v43, 0
    v_mov_b32 v44, 0
    v_mov_b32 v45, 0
    v_mov_b32 v46, 0
    v_mov_b32 v47, 0
    v_mov_b32 v48, 0
    v_mov_b32 v49, 0
    v_mov_b32 v50, 0
    v_mov_b32 v51, 0
    v_mov_b32 v52, 0
    v_mov_b32 v53, 0
    v_mov_b32 v54, 0
    v_mov_b32 v55, 0
    s_sub_u32 s46, s33, 1
    s_cmp_ge_u32 s46, 6
    s_cbranch_scc1 Learly38
    s_lshl_b32 s46, s46, 12
    s_mul_i32 s47, s35, 196608
    s_add_u32 s47, s47, s46
    v_add_u32 v7, s47, v3
    s_add_u32 m0, s46, 0
    s_mov_b32 s44, 12582912
    buffer_load_dwordx4 v7, s[8:11], s44 offen offset:0  lds
    buffer_load_dwordx4 v7, s[8:11], s44 offen offset:1024  lds
    buffer_load_dwordx4 v7, s[8:11], s44 offen offset:2048  lds
    buffer_load_dwordx4 v7, s[8:11], s44 offen offset:3072  lds
Learly38:
    s_cmp_lg_u32 s33, 0
    s_cbranch_scc1 Lwo39
    v_and_b32 v200, 63, v0
    v_and_b32 v200, 31, v200
    v_lshlrev_b32 v200, 3, v200
    s_lshl_b32 s42, s34, 8
    s_add_u32 s42, s42, 48238592
    s_lshl_b32 s43, s32, 11
    s_add_u32 s42, s42, s43
    v_add_u32 v200, s42, v200
    s_mov_b32 s43, 0
Lpl42:
    buffer_load_dwordx2 v[202:203], v200, s[8:11], 0 offen sc1
    s_add_u32 s43, s43, 1
    s_cmp_gt_u32 s43, 500000
    s_cbranch_scc1 Lwf41
    s_waitcnt vmcnt(0)
    v_and_b32 v201, -16, v202
    v_xor_b32 v201, s6, v201
    v_xor_b32 v204, s7, v203
    v_or_b32 v201, v201, v204
    v_cmp_ne_u32 vcc, 0, v201
    s_cbranch_vccnz Lpl42
Lwf41:
    s_waitcnt vmcnt(0)
Lwo39:
    s_barrier
    s_mov_b32 s45, 0
    buffer_load_dwordx4 v[56:59], v2, s[8:11], s45 offen sc1
    s_add_u32 m0, s57, 24576
    s_mov_b32 s44, 12607488
    buffer_load_dwordx4 v236, s[8:11], s44 offen offset:0  lds
    buffer_load_dwordx4 v236, s[8:11], s44 offen offset:1024  lds
    buffer_load_dwordx4 v236, s[8:11], s44 offen offset:2048  lds
    s_mov_b32 s45, 12288
    buffer_load_dwordx4 v[60:63], v2, s[8:11], s45 offen sc1
    s_waitcnt vmcnt(4)
    s_barrier
    ds_read_b128 v[152:155], v3 offset:0
    ds_read_b128 v[156:159], v3 offset:1024
    ds_read_b128 v[160:163], v3 offset:2048
    ds_read_b128 v[164:167], v3 offset:3072
    ds_read_b128 v[168:171], v3 offset:4096
    ds_read_b128 v[172:175], v3 offset:5120
    s_waitcnt lgkmcnt(3)
    v_mfma_f32_32x32x16_bf16 v[8:23], v[152:155], v[56:59], v[8:23]
    v_mfma_f32_32x32x16_bf16 v[24:39], v[156:159], v[56:59], v[24:39]
    v_mfma_f32_32x32x16_bf16 v[40:55], v[56:59], v[160:163], v[40:55]
    s_mov_b32 s45, 24576
    buffer_load_dwordx4 v[64:67], v2, s[8:11], s45 offen sc1
    s_mov_b32 s45, 36864
    buffer_load_dwordx4 v[68:71], v2, s[8:11], s45 offen sc1
    s_mov_b32 s45, 49152
    buffer_load_dwordx4 v[72:75], v2, s[8:11], s45 offen sc1
    ds_read_b128 v[152:155], v3 offset:6144
    ds_read_b128 v[156:159], v3 offset:7168
    ds_read_b128 v[160:163], v3 offset:8192
    s_waitcnt lgkmcnt(3)
    s_waitcnt vmcnt(3)
    v_mfma_f32_32x32x16_bf16 v[8:23], v[164:167], v[60:63], v[8:23]
    v_mfma_f32_32x32x16_bf16 v[24:39], v[168:171], v[60:63], v[24:39]
    v_mfma_f32_32x32x16_bf16 v[40:55], v[60:63], v[172:175], v[40:55]
    s_mov_b32 s45, 61440
    buffer_load_dwordx4 v[76:79], v2, s[8:11], s45 offen sc1
    s_mov_b32 s45, 73728
    buffer_load_dwordx4 v[80:83], v2, s[8:11], s45 offen sc1
    s_mov_b32 s45, 86016
    buffer_load_dwordx4 v[84:87], v2, s[8:11], s45 offen sc1
    ds_read_b128 v[164:167], v3 offset:9216
    ds_read_b128 v[168:171], v3 offset:10240
    ds_read_b128 v[172:175], v3 offset:11264
    s_waitcnt lgkmcnt(3)
    s_waitcnt vmcnt(5)
    v_mfma_f32_32x32x16_bf16 v[8:23], v[152:155], v[64:67], v[8:23]
    v_mfma_f32_32x32x16_bf16 v[24:39], v[156:159], v[64:67], v[24:39]
    v_mfma_f32_32x32x16_bf16 v[40:55], v[64:67], v[160:163], v[40:55]
    s_mov_b32 s45, 98304
    buffer_load_dwordx4 v[88:91], v2, s[8:11], s45 offen sc1
    s_mov_b32 s45, 110592
    buffer_load_dwordx4 v[92:95], v2, s[8:11], s45 offen sc1
    s_mov_b32 s45, 122880
    buffer_load_dwordx4 v[96:99], v2, s[8:11], s45 offen sc1
    ds_read_b128 v[152:155], v3 offset:12288
    ds_read_b128 v[156:159], v3 offset:13312
    ds_read_b128 v[160:163], v3 offset:14336
    s_waitcnt lgkmcnt(3)
    s_waitcnt vmcnt(7)
    v_mfma_f32_32x32x16_bf16 v[8:23], v[164:167], v[68:71], v[8:23]
    v_mfma_f32_32x32x16_bf16 v[24:39], v[168:171], v[68:71], v[24:39]
    v_mfma_f32_32x32x16_bf16 v[40:55], v[68:71], v[172:175], v[40:55]
    s_mov_b32 s45, 135168
    buffer_load_dwordx4 v[100:103], v2, s[8:11], s45 offen sc1
    s_mov_b32 s45, 147456
    buffer_load_dwordx4 v[104:107], v2, s[8:11], s45 offen sc1
    s_mov_b32 s45, 159744
    buffer_load_dwordx4 v[108:111], v2, s[8:11], s45 offen sc1
    s_barrier
    s_add_u32 m0, s57, 49152
    s_mov_b32 s44, 12632064
    buffer_load_dwordx4 v236, s[8:11], s44 offen offset:0  lds
    ds_read_b128 v[164:167], v3 offset:15360
    ds_read_b128 v[168:171], v3 offset:16384
    ds_read_b128 v[172:175], v3 offset:17408
    s_waitcnt lgkmcnt(3)
    s_waitcnt vmcnt(10)
    v_mfma_f32_32x32x16_bf16 v[8:23], v[152:155], v[72:75], v[8:23]
    v_mfma_f32_32x32x16_bf16 v[24:39], v[156:159], v[72:75], v[24:39]
    v_mfma_f32_32x32x16_bf16 v[40:55], v[72:75], v[160:163], v[40:55]
    s_mov_b32 s45, 172032
    buffer_load_dwordx4 v[112:115], v2, s[8:11], s45 offen sc1
    s_mov_b32 s45, 184320
    buffer_load_dwordx4 v[116:119], v2, s[8:11], s45 offen sc1
    s_mov_b32 s45, 196608
    buffer_load_dwordx4 v[120:123], v2, s[8:11], s45 offen sc1
    s_add_u32 m0, s57, 49152
    s_mov_b32 s44, 12632064
    buffer_load_dwordx4 v236, s[8:11], s44 offen offset:1024  lds
    ds_read_b128 v[152:155], v3 offset:18432
    ds_read_b128 v[156:159], v3 offset:19456
    ds_read_b128 v[160:163], v3 offset:20480
    s_waitcnt lgkmcnt(3)
    s_waitcnt vmcnt(13)
    v_mfma_f32_32x32x16_bf16 v[8:23], v[164:167], v[76:79], v[8:23]
    v_mfma_f32_32x32x16_bf16 v[24:39], v[168:171], v[76:79], v[24:39]
    v_mfma_f32_32x32x16_bf16 v[40:55], v[76:79], v[172:175], v[40:55]
    s_mov_b32 s45, 208896
    buffer_load_dwordx4 v[124:127], v2, s[8:11], s45 offen sc1
    s_mov_b32 s45, 221184
    buffer_load_dwordx4 v[128:131], v2, s[8:11], s45 offen sc1
    s_mov_b32 s45, 233472
    buffer_load_dwordx4 v[132:135], v2, s[8:11], s45 offen sc1
    s_add_u32 m0, s57, 49152
    s_mov_b32 s44, 12632064
    buffer_load_dwordx4 v236, s[8:11], s44 offen offset:2048  lds
    ds_read_b128 v[164:167], v3 offset:21504
    ds_read_b128 v[168:171], v3 offset:22528
    ds_read_b128 v[172:175], v3 offset:23552
    s_waitcnt lgkmcnt(3)
    s_waitcnt vmcnt(16)
    v_mfma_f32_32x32x16_bf16 v[8:23], v[152:155], v[80:83], v[8:23]
    v_mfma_f32_32x32x16_bf16 v[24:39], v[156:159], v[80:83], v[24:39]
    v_mfma_f32_32x32x16_bf16 v[40:55], v[80:83], v[160:163], v[40:55]
    s_mov_b32 s45, 245760
    buffer_load_dwordx4 v[136:139], v2, s[8:11], s45 offen sc1
    s_mov_b32 s45, 258048
    buffer_load_dwordx4 v[140:143], v2, s[8:11], s45 offen sc1
    s_mov_b32 s45, 270336
    buffer_load_dwordx4 v[144:147], v2, s[8:11], s45 offen sc1
    ds_read_b128 v[152:155], v3 offset:24576
    ds_read_b128 v[156:159], v3 offset:25600
    ds_read_b128 v[160:163], v3 offset:26624
    s_waitcnt lgkmcnt(3)
    s_waitcnt vmcnt(18)
    v_mfma_f32_32x32x16_bf16 v[8:23], v[164:167], v[84:87], v[8:23]
    v_mfma_f32_32x32x16_bf16 v[24:39], v[168:171], v[84:87], v[24:39]
    v_mfma_f32_32x32x16_bf16 v[40:55], v[84:87], v[172:175], v[40:55]
    s_mov_b32 s45, 282624
    buffer_load_dwordx4 v[148:151], v2, s[8:11], s45 offen sc1
    s_mov_b32 s45, 294912
    buffer_load_dwordx4 v[56:59], v2, s[8:11], s45 offen sc1
    s_mov_b32 s45, 307200
    buffer_load_dwordx4 v[60:63], v2, s[8:11], s45 offen sc1
    ds_read_b128 v[164:167], v3 offset:27648
    ds_read_b128 v[168:171], v3 offset:28672
    ds_read_b128 v[172:175], v3 offset:29696
    s_waitcnt lgkmcnt(3)
    s_waitcnt vmcnt(20)
    v_mfma_f32_32x32x16_bf16 v[8:23], v[152:155], v[88:91], v[8:23]
    v_mfma_f32_32x32x16_bf16 v[24:39], v[156:159], v[88:91], v[24:39]
    v_mfma_f32_32x32x16_bf16 v[40:55], v[88:91], v[160:163], v[40:55]
    s_mov_b32 s45, 319488
    buffer_load_dwordx4 v[64:67], v2, s[8:11], s45 offen sc1
    s_mov_b32 s45, 331776
    buffer_load_dwordx4 v[68:71], v2, s[8:11], s45 offen sc1
    s_mov_b32 s45, 344064
    buffer_load_dwordx4 v[72:75], v2, s[8:11], s45 offen sc1
    ds_read_b128 v[152:155], v3 offset:30720
    ds_read_b128 v[156:159], v3 offset:31744
    ds_read_b128 v[160:163], v3 offset:32768
    s_waitcnt lgkmcnt(3)
    s_waitcnt vmcnt(22)
    v_mfma_f32_32x32x16_bf16 v[8:23], v[164:167], v[92:95], v[8:23]
    v_mfma_f32_32x32x16_bf16 v[24:39], v[168:171], v[92:95], v[24:39]
    v_mfma_f32_32x32x16_bf16 v[40:55], v[92:95], v[172:175], v[40:55]
    s_mov_b32 s45, 356352
    buffer_load_dwordx4 v[76:79], v2, s[8:11], s45 offen sc1
    s_mov_b32 s45, 368640
    buffer_load_dwordx4 v[80:83], v2, s[8:11], s45 offen sc1
    s_mov_b32 s45, 380928
    buffer_load_dwordx4 v[84:87], v2, s[8:11], s45 offen sc1
    ds_read_b128 v[164:167], v3 offset:33792
    ds_read_b128 v[168:171], v3 offset:34816
    ds_read_b128 v[172:175], v3 offset:35840
    s_waitcnt lgkmcnt(3)
    s_waitcnt vmcnt(24)
    v_mfma_f32_32x32x16_bf16 v[8:23], v[152:155], v[96:99], v[8:23]
    v_mfma_f32_32x32x16_bf16 v[24:39], v[156:159], v[96:99], v[24:39]
    v_mfma_f32_32x32x16_bf16 v[40:55], v[96:99], v[160:163], v[40:55]
    s_mov_b32 s45, 393216
    buffer_load_dwordx4 v[88:91], v2, s[8:11], s45 offen sc1
    s_mov_b32 s45, 405504
    buffer_load_dwordx4 v[92:95], v2, s[8:11], s45 offen sc1
    s_mov_b32 s45, 417792
    buffer_load_dwordx4 v[96:99], v2, s[8:11], s45 offen sc1
    ds_read_b128 v[152:155], v3 offset:36864
    ds_read_b128 v[156:159], v3 offset:37888
    ds_read_b128 v[160:163], v3 offset:38912
    s_waitcnt lgkmcnt(3)
    s_waitcnt vmcnt(26)
    v_mfma_f32_32x32x16_bf16 v[8:23], v[164:167], v[100:103], v[8:23]
    v_mfma_f32_32x32x16_bf16 v[24:39], v[168:171], v[100:103], v[24:39]
    v_mfma_f32_32x32x16_bf16 v[40:55], v[100:103], v[172:175], v[40:55]
    s_mov_b32 s45, 430080
    buffer_load_dwordx4 v[100:103], v2, s[8:11], s45 offen sc1
    s_waitcnt vmcnt(16)
    s_barrier
    s_add_u32 m0, s57, 73728
    s_mov_b32 s44, 12656640
    buffer_load_dwordx4 v236, s[8:11], s44 offen offset:0  lds
    ds_read_b128 v[164:167], v3 offset:39936
    ds_read_b128 v[168:171], v3 offset:40960
    ds_read_b128 v[172:175], v3 offset:41984
    s_waitcnt lgkmcnt(3)
    v_mfma_f32_32x32x16_bf16 v[8:23], v[152:155], v[104:107], v[8:23]
    v_mfma_f32_32x32x16_bf16 v[24:39], v[156:159], v[104:107], v[24:39]
    v_mfma_f32_32x32x16_bf16 v[40:55], v[104:107], v[160:163], v[40:55]
    s_mov_b32 s45, 442368
    buffer_load_dwordx4 v[104:107], v2, s[8:11], s45 offen sc1
    s_add_u32 m0, s57, 73728
    s_mov_b32 s44, 12656640
    buffer_load_dwordx4 v236, s[8:11], s44 offen offset:1024  lds
    ds_read_b128 v[152:155], v3 offset:43008
    ds_read_b128 v[156:159], v3 offset:44032
    ds_read_b128 v[160:163], v3 offset:45056
    s_waitcnt lgkmcnt(3)
    v_mfma_f32_32x32x16_bf16 v[8:23], v[164:167], v[108:111], v[8:23]
    v_mfma_f32_32x32x16_bf16 v[24:39], v[168:171], v[108:111], v[24:39]
    v_mfma_f32_32x32x16_bf16 v[40:55], v[108:111], v[172:175], v[40:55]
    s_mov_b32 s45, 454656
    buffer_load_dwordx4 v[108:111], v2, s[8:11], s45 offen sc1
    s_add_u32 m0, s57, 73728
    s_mov_b32 s44, 12656640
    buffer_load_dwordx4 v236, s[8:11], s44 offen offset:2048  lds
    ds_read_b128 v[164:167], v3 offset:46080
    ds_read_b128 v[168:171], v3 offset:47104
    ds_read_b128 v[172:175], v3 offset:48128
    s_waitcnt lgkmcnt(3)
    v_mfma_f32_32x32x16_bf16 v[8:23], v[152:155], v[112:115], v[8:23]
    v_mfma_f32_32x32x16_bf16 v[24:39], v[156:159], v[112:115], v[24:39]
    v_mfma_f32_32x32x16_bf16 v[40:55], v[112:115], v[160:163], v[40:55]
    s_mov_b32 s45, 466944
    buffer_load_dwordx4 v[112:115], v2, s[8:11], s45 offen sc1
    ds_read_b128 v[152:155], v228 offset:0
    ds_read_b128 v[156:159], v228 offset:1024
    ds_read_b128 v[160:163], v228 offset:2048
    s_waitcnt lgkmcnt(3)
    v_mfma_f32_32x32x16_bf16 v[8:23], v[164:167], v[116:119], v[8:23]
    v_mfma_f32_32x32x16_bf16 v[24:39], v[168:171], v[116:119], v[24:39]
    v_mfma_f32_32x32x16_bf16 v[40:55], v[116:119], v[172:175], v[40:55]
    s_mov_b32 s45, 479232
    buffer_load_dwordx4 v[116:119], v2, s[8:11], s45 offen sc1
    ds_read_b128 v[164:167], v228 offset:3072
    ds_read_b128 v[168:171], v228 offset:4096
    ds_read_b128 v[172:175], v228 offset:5120
    s_waitcnt lgkmcnt(3)
    v_mfma_f32_32x32x16_bf16 v[8:23], v[152:155], v[120:123], v[8:23]
    v_mfma_f32_32x32x16_bf16 v[24:39], v[156:159], v[120:123], v[24:39]
    v_mfma_f32_32x32x16_bf16 v[40:55], v[120:123], v[160:163], v[40:55]
    s_mov_b32 s45, 491520
    buffer_load_dwordx4 v[120:123], v2, s[8:11], s45 offen sc1
    ds_read_b128 v[152:155], v228 offset:6144
    ds_read_b128 v[156:159], v228 offset:7168
    ds_read_b128 v[160:163], v228 offset:8192
    s_waitcnt lgkmcnt(3)
    v_mfma_f32_32x32x16_bf16 v[8:23], v[164:167], v[124:127], v[8:23]
    v_mfma_f32_32x32x16_bf16 v[24:39], v[168:171], v[124:127], v[24:39]
    v_mfma_f32_32x32x16_bf16 v[40:55], v[124:127], v[172:175], v[40:55]
    s_mov_b32 s45, 503808
    buffer_load_dwordx4 v[124:127], v2, s[8:11], s45 offen sc1
    ds_read_b128 v[164:167], v228 offset:9216
    ds_read_b128 v[168:171], v228 offset:10240
    ds_read_b128 v[172:175], v228 offset:11264
    s_waitcnt lgkmcnt(3)
    v_mfma_f32_32x32x16_bf16 v[8:23], v[152:155], v[128:131], v[8:23]
    v_mfma_f32_32x32x16_bf16 v[24:39], v[156:159], v[128:131], v[24:39]
    v_mfma_f32_32x32x16_bf16 v[40:55], v[128:131], v[160:163], v[40:55]
    s_mov_b32 s45, 516096
    buffer_load_dwordx4 v[128:131], v2, s[8:11], s45 offen sc1
    ds_read_b128 v[152:155], v228 offset:12288
    ds_read_b128 v[156:159], v228 offset:13312
    ds_read_b128 v[160:163], v228 offset:14336
    s_waitcnt lgkmcnt(3)
    v_mfma_f32_32x32x16_bf16 v[8:23], v[164:167], v[132:135], v[8:23]
    v_mfma_f32_32x32x16_bf16 v[24:39], v[168:171], v[132:135], v[24:39]
    v_mfma_f32_32x32x16_bf16 v[40:55], v[132:135], v[172:175], v[40:55]
    s_mov_b32 s45, 528384
    buffer_load_dwordx4 v[132:135], v2, s[8:11], s45 offen sc1
    s_waitcnt vmcnt(6)
    s_barrier
    s_add_u32 m0, s57, 98304
    s_mov_b32 s44, 12681216
    buffer_load_dwordx4 v236, s[8:11], s44 offen offset:0  lds
    ds_read_b128 v[164:167], v228 offset:15360
    ds_read_b128 v[168:171], v228 offset:16384
    ds_read_b128 v[172:175], v228 offset:17408
    s_waitcnt lgkmcnt(3)
    v_mfma_f32_32x32x16_bf16 v[8:23], v[152:155], v[136:139], v[8:23]
    v_mfma_f32_32x32x16_bf16 v[24:39], v[156:159], v[136:139], v[24:39]
    v_mfma_f32_32x32x16_bf16 v[40:55], v[136:139], v[160:163], v[40:55]
    s_mov_b32 s45, 540672
    buffer_load_dwordx4 v[136:139], v2, s[8:11], s45 offen sc1
    s_add_u32 m0, s57, 98304
    s_mov_b32 s44, 12681216
    buffer_load_dwordx4 v236, s[8:11], s44 offen offset:1024  lds
    ds_read_b128 v[152:155], v228 offset:18432
    ds_read_b128 v[156:159], v228 offset:19456
    ds_read_b128 v[160:163], v228 offset:20480
    s_waitcnt lgkmcnt(3)
    v_mfma_f32_32x32x16_bf16 v[8:23], v[164:167], v[140:143], v[8:23]
    v_mfma_f32_32x32x16_bf16 v[24:39], v[168:171], v[140:143], v[24:39]
    v_mfma_f32_32x32x16_bf16 v[40:55], v[140:143], v[172:175], v[40:55]
    s_mov_b32 s45, 552960
    buffer_load_dwordx4 v[140:143], v2, s[8:11], s45 offen sc1
    s_add_u32 m0, s57, 98304
    s_mov_b32 s44, 12681216
    buffer_load_dwordx4 v236, s[8:11], s44 offen offset:2048  lds
    ds_read_b128 v[164:167], v228 offset:21504
    ds_read_b128 v[168:171], v228 offset:22528
    ds_read_b128 v[172:175], v228 offset:23552
    s_waitcnt lgkmcnt(3)
    v_mfma_f32_32x32x16_bf16 v[8:23], v[152:155], v[144:147], v[8:23]
    v_mfma_f32_32x32x16_bf16 v[24:39], v[156:159], v[144:147], v[24:39]
    v_mfma_f32_32x32x16_bf16 v[40:55], v[144:147], v[160:163], v[40:55]
    s_mov_b32 s45, 565248
    buffer_load_dwordx4 v[144:147], v2, s[8:11], s45 offen sc1
    ds_read_b128 v[152:155], v228 offset:24576
    ds_read_b128 v[156:159], v228 offset:25600
    ds_read_b128 v[160:163], v228 offset:26624
    s_waitcnt lgkmcnt(3)
    v_mfma_f32_32x32x16_bf16 v[8:23], v[164:167], v[148:151], v[8:23]
    v_mfma_f32_32x32x16_bf16 v[24:39], v[168:171], v[148:151], v[24:39]
    v_mfma_f32_32x32x16_bf16 v[40:55], v[148:151], v[172:175], v[40:55]
    s_mov_b32 s45, 577536
    buffer_load_dwordx4 v[148:151], v2, s[8:11], s45 offen sc1
    ds_read_b128 v[164:167], v228 offset:27648
    ds_read_b128 v[168:171], v228 offset:28672
    ds_read_b128 v[172:175], v228 offset:29696
    s_waitcnt lgkmcnt(3)
    v_mfma_f32_32x32x16_bf16 v[8:23], v[152:155], v[56:59], v[8:23]
    v_mfma_f32_32x32x16_bf16 v[24:39], v[156:159], v[56:59], v[24:39]
    v_mfma_f32_32x32x16_bf16 v[40:55], v[56:59], v[160:163], v[40:55]
    s_mov_b32 s45, 589824
    buffer_load_dwordx4 v[56:59], v2, s[8:11], s45 offen sc1
    ds_read_b128 v[152:155], v228 offset:30720
    ds_read_b128 v[156:159], v228 offset:31744
    ds_read_b128 v[160:163], v228 offset:32768
    s_waitcnt lgkmcnt(3)
    v_mfma_f32_32x32x16_bf16 v[8:23], v[164:167], v[60:63], v[8:23]
    v_mfma_f32_32x32x16_bf16 v[24:39], v[168:171], v[60:63], v[24:39]
    v_mfma_f32_32x32x16_bf16 v[40:55], v[60:63], v[172:175], v[40:55]
    s_mov_b32 s45, 602112
    buffer_load_dwordx4 v[60:63], v2, s[8:11], s45 offen sc1
    ds_read_b128 v[164:167], v228 offset:33792
    ds_read_b128 v[168:171], v228 offset:34816
    ds_read_b128 v[172:175], v228 offset:35840
    s_waitcnt lgkmcnt(3)
    v_mfma_f32_32x32x16_bf16 v[8:23], v[152:155], v[64:67], v[8:23]
    v_mfma_f32_32x32x16_bf16 v[24:39], v[156:159], v[64:67], v[24:39]
    v_mfma_f32_32x32x16_bf16 v[40:55], v[64:67], v[160:163], v[40:55]
    s_mov_b32 s45, 614400
    buffer_load_dwordx4 v[64:67], v2, s[8:11], s45 offen sc1
    ds_read_b128 v[152:155], v228 offset:36864
    ds_read_b128 v[156:159], v228 offset:37888
    ds_read_b128 v[160:163], v228 offset:38912
    s_waitcnt lgkmcnt(3)
    v_mfma_f32_32x32x16_bf16 v[8:23], v[164:167], v[68:71], v[8:23]
    v_mfma_f32_32x32x16_bf16 v[24:39], v[168:171], v[68:71], v[24:39]
    v_mfma_f32_32x32x16_bf16 v[40:55], v[68:71], v[172:175], v[40:55]
    s_mov_b32 s45, 626688
    buffer_load_dwordx4 v[68:71], v2, s[8:11], s45 offen sc1
    s_waitcnt vmcnt(6)
    s_barrier
    s_add_u32 m0, s57, 0
    s_mov_b32 s44, 12705792
    buffer_load_dwordx4 v236, s[8:11], s44 offen offset:0  lds
    ds_read_b128 v[164:167], v228 offset:39936
    ds_read_b128 v[168:171], v228 offset:40960
    ds_read_b128 v[172:175], v228 offset:41984
    s_waitcnt lgkmcnt(3)
    v_mfma_f32_32x32x16_bf16 v[8:23], v[152:155], v[72:75], v[8:23]
    v_mfma_f32_32x32x16_bf16 v[24:39], v[156:159], v[72:75], v[24:39]
    v_mfma_f32_32x32x16_bf16 v[40:55], v[72:75], v[160:163], v[40:55]
    s_mov_b32 s45, 638976
    buffer_load_dwordx4 v[72:75], v2, s[8:11], s45 offen sc1
    s_add_u32 m0, s57, 0
    s_mov_b32 s44, 12705792
    buffer_load_dwordx4 v236, s[8:11], s44 offen offset:1024  lds
    ds_read_b128 v[152:155], v228 offset:43008
    ds_read_b128 v[156:159], v228 offset:44032
    ds_read_b128 v[160:163], v228 offset:45056
    s_waitcnt lgkmcnt(3)
    v_mfma_f32_32x32x16_bf16 v[8:23], v[164:167], v[76:79], v[8:23]
    v_mfma_f32_32x32x16_bf16 v[24:39], v[168:171], v[76:79], v[24:39]
    v_mfma_f32_32x32x16_bf16 v[40:55], v[76:79], v[172:175], v[40:55]
    s_mov_b32 s45, 651264
    buffer_load_dwordx4 v[76:79], v2, s[8:11], s45 offen sc1
    s_add_u32 m0, s57, 0
    s_mov_b32 s44, 12705792
    buffer_load_dwordx4 v236, s[8:11], s44 offen offset:2048  lds
    ds_read_b128 v[164:167], v228 offset:46080
    ds_read_b128 v[168:171], v228 offset:47104
    ds_read_b128 v[172:175], v228 offset:48128
    s_waitcnt lgkmcnt(3)
    v_mfma_f32_32x32x16_bf16 v[8:23], v[152:155], v[80:83], v[8:23]
    v_mfma_f32_32x32x16_bf16 v[24:39], v[156:159], v[80:83], v[24:39]
    v_mfma_f32_32x32x16_bf16 v[40:55], v[80:83], v[160:163], v[40:55]
    s_mov_b32 s45, 663552
    buffer_load_dwordx4 v[80:83], v2, s[8:11], s45 offen sc1
    ds_read_b128 v[152:155], v229 offset:0
    ds_read_b128 v[156:159], v229 offset:1024
    ds_read_b128 v[160:163], v229 offset:2048
    s_waitcnt lgkmcnt(3)
    v_mfma_f32_32x32x16_bf16 v[8:23], v[164:167], v[84:87], v[8:23]
    v_mfma_f32_32x32x16_bf16 v[24:39], v[168:171], v[84:87], v[24:39]
    v_mfma_f32_32x32x16_bf16 v[40:55], v[84:87], v[172:175], v[40:55]
    s_mov_b32 s45, 675840
    buffer_load_dwordx4 v[84:87], v2, s[8:11], s45 offen sc1
    ds_read_b128 v[164:167], v229 offset:3072
    ds_read_b128 v[168:171], v229 offset:4096
    ds_read_b128 v[172:175], v229 offset:5120
    s_waitcnt lgkmcnt(3)
    v_mfma_f32_32x32x16_bf16 v[8:23], v[152:155], v[88:91], v[8:23]
    v_mfma_f32_32x32x16_bf16 v[24:39], v[156:159], v[88:91], v[24:39]
    v_mfma_f32_32x32x16_bf16 v[40:55], v[88:91], v[160:163], v[40:55]
    s_mov_b32 s45, 688128
    buffer_load_dwordx4 v[88:91], v2, s[8:11], s45 offen sc1
    ds_read_b128 v[152:155], v229 offset:6144
    ds_read_b128 v[156:159], v229 offset:7168
    ds_read_b128 v[160:163], v229 offset:8192
    s_waitcnt lgkmcnt(3)
    v_mfma_f32_32x32x16_bf16 v[8:23], v[164:167], v[92:95], v[8:23]
    v_mfma_f32_32x32x16_bf16 v[24:39], v[168:171], v[92:95], v[24:39]
    v_mfma_f32_32x32x16_bf16 v[40:55], v[92:95], v[172:175], v[40:55]
    s_mov_b32 s45, 700416
    buffer_load_dwordx4 v[92:95], v2, s[8:11], s45 offen sc1
    ds_read_b128 v[164:167], v229 offset:9216
    ds_read_b128 v[168:171], v229 offset:10240
    ds_read_b128 v[172:175], v229 offset:11264
    s_waitcnt lgkmcnt(3)
    v_mfma_f32_32x32x16_bf16 v[8:23], v[152:155], v[96:99], v[8:23]
    v_mfma_f32_32x32x16_bf16 v[24:39], v[156:159], v[96:99], v[24:39]
    v_mfma_f32_32x32x16_bf16 v[40:55], v[96:99], v[160:163], v[40:55]
    s_mov_b32 s45, 712704
    buffer_load_dwordx4 v[96:99], v2, s[8:11], s45 offen sc1
    ds_read_b128 v[152:155], v229 offset:12288
    ds_read_b128 v[156:159], v229 offset:13312
    ds_read_b128 v[160:163], v229 offset:14336
    s_waitcnt lgkmcnt(3)
    v_mfma_f32_32x32x16_bf16 v[8:23], v[164:167], v[100:103], v[8:23]
    v_mfma_f32_32x32x16_bf16 v[24:39], v[168:171], v[100:103], v[24:39]
    v_mfma_f32_32x32x16_bf16 v[40:55], v[100:103], v[172:175], v[40:55]
    s_mov_b32 s45, 724992
    buffer_load_dwordx4 v[100:103], v2, s[8:11], s45 offen sc1
    s_waitcnt vmcnt(6)
    s_barrier
    s_add_u32 m0, s57, 24576
    s_mov_b32 s44, 12730368
    buffer_load_dwordx4 v236, s[8:11], s44 offen offset:0  lds
    ds_read_b128 v[164:167], v229 offset:15360
    ds_read_b128 v[168:171], v229 offset:16384
    ds_read_b128 v[172:175], v229 offset:17408
    s_waitcnt lgkmcnt(3)
    v_mfma_f32_32x32x16_bf16 v[8:23], v[152:155], v[104:107], v[8:23]
    v_mfma_f32_32x32x16_bf16 v[24:39], v[156:159], v[104:107], v[24:39]
    v_mfma_f32_32x32x16_bf16 v[40:55], v[104:107], v[160:163], v[40:55]
    s_mov_b32 s45, 737280
    buffer_load_dwordx4 v[104:107], v2, s[8:11], s45 offen sc1
    s_add_u32 m0, s57, 24576
    s_mov_b32 s44, 12730368
    buffer_load_dwordx4 v236, s[8:11], s44 offen offset:1024  lds
    ds_read_b128 v[152:155], v229 offset:18432
    ds_read_b128 v[156:159], v229 offset:19456
    ds_read_b128 v[160:163], v229 offset:20480
    s_waitcnt lgkmcnt(3)
    v_mfma_f32_32x32x16_bf16 v[8:23], v[164:167], v[108:111], v[8:23]
    v_mfma_f32_32x32x16_bf16 v[24:39], v[168:171], v[108:111], v[24:39]
    v_mfma_f32_32x32x16_bf16 v[40:55], v[108:111], v[172:175], v[40:55]
    s_mov_b32 s45, 749568
    buffer_load_dwordx4 v[108:111], v2, s[8:11], s45 offen sc1
    s_add_u32 m0, s57, 24576
    s_mov_b32 s44, 12730368
    buffer_load_dwordx4 v236, s[8:11], s44 offen offset:2048  lds
    ds_read_b128 v[164:167], v229 offset:21504
    ds_read_b128 v[168:171], v229 offset:22528
    ds_read_b128 v[172:175], v229 offset:23552
    s_waitcnt lgkmcnt(3)
    v_mfma_f32_32x32x16_bf16 v[8:23], v[152:155], v[112:115], v[8:23]
    v_mfma_f32_32x32x16_bf16 v[24:39], v[156:159], v[112:115], v[24:39]
    v_mfma_f32_32x32x16_bf16 v[40:55], v[112:115], v[160:163], v[40:55]
    s_mov_b32 s45, 761856
    buffer_load_dwordx4 v[112:115], v2, s[8:11], s45 offen sc1
    ds_read_b128 v[152:155], v3 offset:0
    ds_read_b128 v[156:159], v3 offset:1024
    ds_read_b128 v[160:163], v3 offset:2048
    s_waitcnt lgkmcnt(3)
    v_mfma_f32_32x32x16_bf16 v[8:23], v[164:167], v[116:119], v[8:23]
    v_mfma_f32_32x32x16_bf16 v[24:39], v[168:171], v[116:119], v[24:39]
    v_mfma_f32_32x32x16_bf16 v[40:55], v[116:119], v[172:175], v[40:55]
    s_mov_b32 s45, 774144
    buffer_load_dwordx4 v[116:119], v2, s[8:11], s45 offen sc1
    ds_read_b128 v[164:167], v3 offset:3072
    ds_read_b128 v[168:171], v3 offset:4096
    ds_read_b128 v[172:175], v3 offset:5120
    s_waitcnt lgkmcnt(3)
    v_mfma_f32_32x32x16_bf16 v[8:23], v[152:155], v[120:123], v[8:23]
    v_mfma_f32_32x32x16_bf16 v[24:39], v[156:159], v[120:123], v[24:39]
    v_mfma_f32_32x32x16_bf16 v[40:55], v[120:123], v[160:163], v[40:55]
    ds_read_b128 v[152:155], v3 offset:6144
    ds_read_b128 v[156:159], v3 offset:7168
    ds_read_b128 v[160:163], v3 offset:8192
    s_waitcnt lgkmcnt(3)
    v_mfma_f32_32x32x16_bf16 v[8:23], v[164:167], v[124:127], v[8:23]
    v_mfma_f32_32x32x16_bf16 v[24:39], v[168:171], v[124:127], v[24:39]
    v_mfma_f32_32x32x16_bf16 v[40:55], v[124:127], v[172:175], v[40:55]
    ds_read_b128 v[164:167], v3 offset:9216
    ds_read_b128 v[168:171], v3 offset:10240
    ds_read_b128 v[172:175], v3 offset:11264
    s_waitcnt lgkmcnt(3)
    v_mfma_f32_32x32x16_bf16 v[8:23], v[152:155], v[128:131], v[8:23]
    v_mfma_f32_32x32x16_bf16 v[24:39], v[156:159], v[128:131], v[24:39]
    v_mfma_f32_32x32x16_bf16 v[40:55], v[128:131], v[160:163], v[40:55]
    ds_read_b128 v[152:155], v3 offset:12288
    ds_read_b128 v[156:159], v3 offset:13312
    ds_read_b128 v[160:163], v3 offset:14336
    s_waitcnt lgkmcnt(3)
    v_mfma_f32_32x32x16_bf16 v[8:23], v[164:167], v[132:135], v[8:23]
    v_mfma_f32_32x32x16_bf16 v[24:39], v[168:171], v[132:135], v[24:39]
    v_mfma_f32_32x32x16_bf16 v[40:55], v[132:135], v[172:175], v[40:55]
    s_waitcnt vmcnt(2)
    s_barrier
    s_add_u32 m0, s57, 49152
    s_mov_b32 s44, 12754944
    buffer_load_dwordx4 v236, s[8:11], s44 offen offset:0  lds
    ds_read_b128 v[164:167], v3 offset:15360
    ds_read_b128 v[168:171], v3 offset:16384
    ds_read_b128 v[172:175], v3 offset:17408
    s_waitcnt lgkmcnt(3)
    v_mfma_f32_32x32x16_bf16 v[8:23], v[152:155], v[136:139], v[8:23]
    v_mfma_f32_32x32x16_bf16 v[24:39], v[156:159], v[136:139], v[24:39]
    v_mfma_f32_32x32x16_bf16 v[40:55], v[136:139], v[160:163], v[40:55]
    s_add_u32 m0, s57, 49152
    s_mov_b32 s44, 12754944
    buffer_load_dwordx4 v236, s[8:11], s44 offen offset:1024  lds
    ds_read_b128 v[152:155], v3 offset:18432
    ds_read_b128 v[156:159], v3 offset:19456
    ds_read_b128 v[160:163], v3 offset:20480
    s_waitcnt lgkmcnt(3)
    v_mfma_f32_32x32x16_bf16 v[8:23], v[164:167], v[140:143], v[8:23]
    v_mfma_f32_32x32x16_bf16 v[24:39], v[168:171], v[140:143], v[24:39]
    v_mfma_f32_32x32x16_bf16 v[40:55], v[140:143], v[172:175], v[40:55]
    s_add_u32 m0, s57, 49152
    s_mov_b32 s44, 12754944
    buffer_load_dwordx4 v236, s[8:11], s44 offen offset:2048  lds
    ds_read_b128 v[164:167], v3 offset:21504
    ds_read_b128 v[168:171], v3 offset:22528
    ds_read_b128 v[172:175], v3 offset:23552
    s_waitcnt lgkmcnt(3)
    v_mfma_f32_32x32x16_bf16 v[8:23], v[152:155], v[144:147], v[8:23]
    v_mfma_f32_32x32x16_bf16 v[24:39], v[156:159], v[144:147], v[24:39]
    v_mfma_f32_32x32x16_bf16 v[40:55], v[144:147], v[160:163], v[40:55]
    ds_read_b128 v[152:155], v3 offset:24576
    ds_read_b128 v[156:159], v3 offset:25600
    ds_read_b128 v[160:163], v3 offset:26624
    s_waitcnt lgkmcnt(3)
    v_mfma_f32_32x32x16_bf16 v[8:23], v[164:167], v[148:151], v[8:23]
    v_mfma_f32_32x32x16_bf16 v[24:39], v[168:171], v[148:151], v[24:39]
    v_mfma_f32_32x32x16_bf16 v[40:55], v[148:151], v[172:175], v[40:55]
    ds_read_b128 v[164:167], v3 offset:27648
    ds_read_b128 v[168:171], v3 offset:28672
    ds_read_b128 v[172:175], v3 offset:29696
    s_waitcnt lgkmcnt(3)
    v_mfma_f32_32x32x16_bf16 v[8:23], v[152:155], v[56:59], v[8:23]
    v_mfma_f32_32x32x16_bf16 v[24:39], v[156:159], v[56:59], v[24:39]
    v_mfma_f32_32x32x16_bf16 v[40:55], v[56:59], v[160:163], v[40:55]
    ds_read_b128 v[152:155], v3 offset:30720
    ds_read_b128 v[156:159], v3 offset:31744
    ds_read_b128 v[160:163], v3 offset:32768
    s_waitcnt lgkmcnt(3)
    v_mfma_f32_32x32x16_bf16 v[8:23], v[164:167], v[60:63], v[8:23]
    v_mfma_f32_32x32x16_bf16 v[24:39], v[168:171], v[60:63], v[24:39]
    v_mfma_f32_32x32x16_bf16 v[40:55], v[60:63], v[172:175], v[40:55]
    ds_read_b128 v[164:167], v3 offset:33792
    ds_read_b128 v[168:171], v3 offset:34816
    ds_read_b128 v[172:175], v3 offset:35840
    s_waitcnt lgkmcnt(3)
    v_mfma_f32_32x32x16_bf16 v[8:23], v[152:155], v[64:67], v[8:23]
    v_mfma_f32_32x32x16_bf16 v[24:39], v[156:159], v[64:67], v[24:39]
    v_mfma_f32_32x32x16_bf16 v[40:55], v[64:67], v[160:163], v[40:55]
    ds_read_b128 v[152:155], v3 offset:36864
    ds_read_b128 v[156:159], v3 offset:37888
    ds_read_b128 v[160:163], v3 offset:38912
    s_waitcnt lgkmcnt(3)
    v_mfma_f32_32x32x16_bf16 v[8:23], v[164:167], v[68:71], v[8:23]
    v_mfma_f32_32x32x16_bf16 v[24:39], v[168:171], v[68:71], v[24:39]
    v_mfma_f32_32x32x16_bf16 v[40:55], v[68:71], v[172:175], v[40:55]
    s_waitcnt vmcnt(0)
    s_barrier
    ds_read_b128 v[164:167], v3 offset:39936
    ds_read_b128 v[168:171], v3 offset:40960
    ds_read_b128 v[172:175], v3 offset:41984
    s_waitcnt lgkmcnt(3)
    v_mfma_f32_32x32x16_bf16 v[8:23], v[152:155], v[72:75], v[8:23]
    v_mfma_f32_32x32x16_bf16 v[24:39], v[156:159], v[72:75], v[24:39]
    v_mfma_f32_32x32x16_bf16 v[40:55], v[72:75], v[160:163], v[40:55]
    ds_read_b128 v[152:155], v3 offset:43008
    ds_read_b128 v[156:159], v3 offset:44032
    ds_read_b128 v[160:163], v3 offset:45056
    s_waitcnt lgkmcnt(3)
    v_mfma_f32_32x32x16_bf16 v[8:23], v[164:167], v[76:79], v[8:23]
    v_mfma_f32_32x32x16_bf16 v[24:39], v[168:171], v[76:79], v[24:39]
    v_mfma_f32_32x32x16_bf16 v[40:55], v[76:79], v[172:175], v[40:55]
    ds_read_b128 v[164:167], v3 offset:46080
    ds_read_b128 v[168:171], v3 offset:47104
    ds_read_b128 v[172:175], v3 offset:48128
    s_waitcnt lgkmcnt(3)
    v_mfma_f32_32x32x16_bf16 v[8:23], v[152:155], v[80:83], v[8:23]
    v_mfma_f32_32x32x16_bf16 v[24:39], v[156:159], v[80:83], v[24:39]
    v_mfma_f32_32x32x16_bf16 v[40:55], v[80:83], v[160:163], v[40:55]
    ds_read_b128 v[152:155], v228 offset:0
    ds_read_b128 v[156:159], v228 offset:1024
    ds_read_b128 v[160:163], v228 offset:2048
    s_waitcnt lgkmcnt(3)
    v_mfma_f32_32x32x16_bf16 v[8:23], v[164:167], v[84:87], v[8:23]
    v_mfma_f32_32x32x16_bf16 v[24:39], v[168:171], v[84:87], v[24:39]
    v_mfma_f32_32x32x16_bf16 v[40:55], v[84:87], v[172:175], v[40:55]
    ds_read_b128 v[164:167], v228 offset:3072
    ds_read_b128 v[168:171], v228 offset:4096
    ds_read_b128 v[172:175], v228 offset:5120
    s_waitcnt lgkmcnt(3)
    v_mfma_f32_32x32x16_bf16 v[8:23], v[152:155], v[88:91], v[8:23]
    v_mfma_f32_32x32x16_bf16 v[24:39], v[156:159], v[88:91], v[24:39]
    v_mfma_f32_32x32x16_bf16 v[40:55], v[88:91], v[160:163], v[40:55]
    s_cmp_lg_u32 s33, 0
    s_cbranch_scc1 Ltc43
    v_and_b32 v239, 63, v0
    s_mul_i32 s42, s35, 24576
    s_mul_i32 s43, s34, 786432
    s_add_u32 s42, s42, s43
    s_add_u32 s42, s42, 0
    v_lshrrev_b32 v238, 5, v239
    v_mul_u32_u24 v238, 6144, v238
    v_and_b32 v239, 31, v239
    v_lshl_add_u32 v238, v239, 7, v238
    v_add_u32 v238, s42, v238
    buffer_load_dword v239, v238, s[8:11], 0 offen sc1
Ltc43:
    s_cmp_lg_u32 s33, 1
    s_cbranch_scc1 Ltc44
    v_and_b32 v239, 63, v0
    s_mul_i32 s42, s35, 24576
    s_mul_i32 s43, s34, 786432
    s_add_u32 s42, s42, s43
    s_add_u32 s42, s42, 12288
    v_lshrrev_b32 v238, 5, v239
    v_mul_u32_u24 v238, 6144, v238
    v_and_b32 v239, 31, v239
    v_lshl_add_u32 v238, v239, 7, v238
    v_add_u32 v238, s42, v238
    buffer_load_dword v239, v238, s[8:11], 0 offen sc1
Ltc44:
    ds_read_b128 v[152:155], v228 offset:6144
    ds_read_b128 v[156:159], v228 offset:7168
    ds_read_b128 v[160:163], v228 offset:8192
    s_waitcnt lgkmcnt(3)
    v_mfma_f32_32x32x16_bf16 v[8:23], v[164:167], v[92:95], v[8:23]
    v_mfma_f32_32x32x16_bf16 v[24:39], v[168:171], v[92:95], v[24:39]
    v_mfma_f32_32x32x16_bf16 v[40:55], v[92:95], v[172:175], v[40:55]
    ds_read_b128 v[164:167], v228 offset:9216
    ds_read_b128 v[168:171], v228 offset:10240
    ds_read_b128 v[172:175], v228 offset:11264
    s_waitcnt lgkmcnt(3)
    v_mfma_f32_32x32x16_bf16 v[8:23], v[152:155], v[96:99], v[8:23]
    v_mfma_f32_32x32x16_bf16 v[24:39], v[156:159], v[96:99], v[24:39]
    v_mfma_f32_32x32x16_bf16 v[40:55], v[96:99], v[160:163], v[40:55]
    ds_read_b128 v[152:155], v228 offset:12288
    ds_read_b128 v[156:159], v228 offset:13312
    ds_read_b128 v[160:163], v228 offset:14336
    s_waitcnt lgkmcnt(3)
    v_mfma_f32_32x32x16_bf16 v[8:23], v[164:167], v[100:103], v[8:23]
    v_mfma_f32_32x32x16_bf16 v[24:39], v[168:171], v[100:103], v[24:39]
    v_mfma_f32_32x32x16_bf16 v[40:55], v[100:103], v[172:175], v[40:55]
    ds_read_b128 v[164:167], v228 offset:15360
    ds_read_b128 v[168:171], v228 offset:16384
    ds_read_b128 v[172:175], v228 offset:17408
    s_waitcnt lgkmcnt(3)
    v_mfma_f32_32x32x16_bf16 v[8:23], v[152:155], v[104:107], v[8:23]
    v_mfma_f32_32x32x16_bf16 v[24:39], v[156:159], v[104:107], v[24:39]
    v_mfma_f32_32x32x16_bf16 v[40:55], v[104:107], v[160:163], v[40:55]
    ds_read_b128 v[152:155], v228 offset:18432
    ds_read_b128 v[156:159], v228 offset:19456
    ds_read_b128 v[160:163], v228 offset:20480
    s_waitcnt lgkmcnt(3)
    v_mfma_f32_32x32x16_bf16 v[8:23], v[164:167], v[108:111], v[8:23]
    v_mfma_f32_32x32x16_bf16 v[24:39], v[168:171], v[108:111], v[24:39]
    v_mfma_f32_32x32x16_bf16 v[40:55], v[108:111], v[172:175], v[40:55]
    ds_read_b128 v[164:167], v228 offset:21504
    ds_read_b128 v[168:171], v228 offset:22528
    ds_read_b128 v[172:175], v228 offset:23552
    s_waitcnt lgkmcnt(3)
    v_mfma_f32_32x32x16_bf16 v[8:23], v[152:155], v[112:115], v[8:23]
    v_mfma_f32_32x32x16_bf16 v[24:39], v[156:159], v[112:115], v[24:39]
    v_mfma_f32_32x32x16_bf16 v[40:55], v[112:115], v[160:163], v[40:55]
    s_waitcnt lgkmcnt(0)
    v_mfma_f32_32x32x16_bf16 v[8:23], v[164:167], v[116:119], v[8:23]
    v_mfma_f32_32x32x16_bf16 v[24:39], v[168:171], v[116:119], v[24:39]
    v_mfma_f32_32x32x16_bf16 v[40:55], v[116:119], v[172:175], v[40:55]
    s_nop 10
    v_cvt_pk_bf16_f32 v56, v24, v25
    v_cvt_pk_bf16_f32 v57, v26, v27
    v_cvt_pk_bf16_f32 v58, v28, v29
    v_cvt_pk_bf16_f32 v59, v30, v31
    v_cvt_pk_bf16_f32 v60, v32, v33
    v_cvt_pk_bf16_f32 v61, v34, v35
    v_cvt_pk_bf16_f32 v62, v36, v37
    v_cvt_pk_bf16_f32 v63, v38, v39
    v_mfma_f32_32x32x16_bf16 v[72:87], v[240:243], v[56:59], 0
    s_nop 0
    v_mfma_f32_32x32x16_bf16 v[72:87], v[244:247], v[60:63], v[72:87]
    s_lshr_b32 s58, s35, 1
    s_and_b32 s59, s33, 3
    s_lshr_b32 s60, s33, 2
    s_lshl_b32 s61, s59, 12
    s_lshl_b32 s62, s60, 14
    s_add_u32 s61, s61, s62
    s_lshl_b32 s62, s59, 12
    s_lshl_b32 s63, s60, 16
    s_add_u32 s62, s62, s63
    s_mul_i32 s63, s58, 131072
    s_add_u32 s62, s62, s63
    v_and_b32 v237, 63, v0
    v_lshl_add_u32 v237, v237, 4, s62
    s_add_u32 m0, s61, 73728
    s_mov_b32 s44, 18874368
    buffer_load_dwordx4 v237, s[8:11], s44 offen offset:0  lds
    buffer_load_dwordx4 v237, s[8:11], s44 offen offset:1024  lds
    buffer_load_dwordx4 v237, s[8:11], s44 offen offset:2048  lds
    buffer_load_dwordx4 v237, s[8:11], s44 offen offset:3072  lds
    s_add_u32 m0, s61, 106496
    s_mov_b32 s44, 18890752
    buffer_load_dwordx4 v237, s[8:11], s44 offen offset:0  lds
    buffer_load_dwordx4 v237, s[8:11], s44 offen offset:1024  lds
    buffer_load_dwordx4 v237, s[8:11], s44 offen offset:2048  lds
    buffer_load_dwordx4 v237, s[8:11], s44 offen offset:3072  lds
    v_cvt_pk_bf16_f32 v64, v40, v41
    v_cvt_pk_bf16_f32 v65, v42, v43
    v_cvt_pk_bf16_f32 v66, v44, v45
    v_cvt_pk_bf16_f32 v67, v46, v47
    v_cvt_pk_bf16_f32 v68, v48, v49
    v_cvt_pk_bf16_f32 v69, v50, v51
    v_cvt_pk_bf16_f32 v70, v52, v53
    v_cvt_pk_bf16_f32 v71, v54, v55
    v_mov_b32 v128, 0x3f803f80
    v_mov_b32 v129, 0x3f803f80
    v_mov_b32 v130, 0x3f803f80
    v_mov_b32 v131, 0x3f803f80
    v_max3_f32 v104, v72, v73, v74
    v_min3_f32 v105, v72, v73, v74
    v_max3_f32 v104, v104, v75, v76
    v_min3_f32 v105, v105, v75, v76
    v_max3_f32 v104, v104, v77, v78
    v_min3_f32 v105, v105, v77, v78
    v_max3_f32 v104, v104, v79, v80
    v_min3_f32 v105, v105, v79, v80
    v_max3_f32 v104, v104, v81, v82
    v_min3_f32 v105, v105, v81, v82
    v_max3_f32 v104, v104, v83, v84
    v_min3_f32 v105, v105, v83, v84
    v_max3_f32 v104, v104, v85, v86
    v_min3_f32 v105, v105, v85, v86
    v_max_f32 v104, v104, v87
    v_min_f32 v105, v105, v87
    v_mov_b32 v106, v104
    v_mov_b32 v107, v105
    s_nop 0
    v_permlane32_swap_b32 v104, v106
    v_permlane32_swap_b32 v105, v107
    v_max_f32 v104, v104, v106
    v_min_f32 v105, v105, v107
    v_mul_f32 v106, s41, v104
    v_mul_f32 v110, s40, v105
    v_mul_f32 v107, s41, v104
    v_mul_f32 v111, s40, v105
    v_pk_fma_f32 v[132:133], v[72:73], s[24:25], v[106:107]
    v_pk_fma_f32 v[148:149], v[72:73], s[26:27], v[110:111]
    v_pk_fma_f32 v[134:135], v[74:75], s[24:25], v[106:107]
    v_pk_fma_f32 v[150:151], v[74:75], s[26:27], v[110:111]
    v_pk_fma_f32 v[136:137], v[76:77], s[24:25], v[106:107]
    v_pk_fma_f32 v[152:153], v[76:77], s[26:27], v[110:111]
    v_pk_fma_f32 v[138:139], v[78:79], s[24:25], v[106:107]
    v_pk_fma_f32 v[154:155], v[78:79], s[26:27], v[110:111]
    v_pk_fma_f32 v[140:141], v[80:81], s[24:25], v[106:107]
    v_pk_fma_f32 v[156:157], v[80:81], s[26:27], v[110:111]
    v_pk_fma_f32 v[142:143], v[82:83], s[24:25], v[106:107]
    v_pk_fma_f32 v[158:159], v[82:83], s[26:27], v[110:111]
    v_pk_fma_f32 v[144:145], v[84:85], s[24:25], v[106:107]
    v_pk_fma_f32 v[160:161], v[84:85], s[26:27], v[110:111]
    v_pk_fma_f32 v[146:147], v[86:87], s[24:25], v[106:107]
    v_pk_fma_f32 v[162:163], v[86:87], s[26:27], v[110:111]
    v_exp_f32 v132, v132
    v_exp_f32 v148, v148
    v_exp_f32 v133, v133
    v_exp_f32 v149, v149
    v_exp_f32 v134, v134
    v_exp_f32 v150, v150
    v_exp_f32 v135, v135
    v_exp_f32 v151, v151
    v_exp_f32 v136, v136
    v_exp_f32 v152, v152
    v_exp_f32 v137, v137
    v_exp_f32 v153, v153
    v_exp_f32 v138, v138
    v_exp_f32 v154, v154
    v_exp_f32 v139, v139
    v_exp_f32 v155, v155
    v_exp_f32 v140, v140
    v_exp_f32 v156, v156
    v_exp_f32 v141, v141
    v_exp_f32 v157, v157
    v_exp_f32 v142, v142
    v_exp_f32 v158, v158
    v_exp_f32 v143, v143
    v_exp_f32 v159, v159
    v_exp_f32 v144, v144
    v_exp_f32 v160, v160
    v_exp_f32 v145, v145
    v_exp_f32 v161, v161
    v_exp_f32 v146, v146
    v_exp_f32 v162, v162
    v_exp_f32 v147, v147
    v_exp_f32 v163, v163
    v_add_f32 v108, v132, v133
    v_add_f32 v109, v148, v149
    v_add_f32 v110, v134, v135
    v_add_f32 v111, v150, v151
    v_add_f32 v108, v108, v136
    v_add_f32 v109, v109, v152
    v_add_f32 v110, v110, v137
    v_add_f32 v111, v111, v153
    v_add_f32 v108, v108, v138
    v_add_f32 v109, v109, v154
    v_add_f32 v110, v110, v139
    v_add_f32 v111, v111, v155
    v_add_f32 v108, v108, v140
    v_add_f32 v109, v109, v156
    v_add_f32 v110, v110, v141
    v_add_f32 v111, v111, v157
    v_add_f32 v108, v108, v142
    v_add_f32 v109, v109, v158
    v_add_f32 v110, v110, v143
    v_add_f32 v111, v111, v159
    v_add_f32 v108, v108, v144
    v_add_f32 v109, v109, v160
    v_add_f32 v110, v110, v145
    v_add_f32 v111, v111, v161
    v_add_f32 v108, v108, v146
    v_add_f32 v109, v109, v162
    v_add_f32 v110, v110, v147
    v_add_f32 v111, v111, v163
    v_add_f32 v108, v108, v110
    v_add_f32 v109, v109, v111
    v_mov_b32 v106, v108
    v_mov_b32 v107, v109
    s_nop 0
    v_permlane32_swap_b32 v108, v106
    v_permlane32_swap_b32 v109, v107
    v_add_f32 v108, v108, v106
    v_add_f32 v109, v109, v107
    v_rcp_f32 v109, v109
    v_rcp_f32 v108, v108
    s_nop 0
    v_mul_f32 v132, v132, v108
    v_mul_f32 v148, v148, v109
    v_mul_f32 v133, v133, v108
    v_mul_f32 v149, v149, v109
    v_mul_f32 v134, v134, v108
    v_mul_f32 v150, v150, v109
    v_mul_f32 v135, v135, v108
    v_mul_f32 v151, v151, v109
    v_mul_f32 v136, v136, v108
    v_mul_f32 v152, v152, v109
    v_mul_f32 v137, v137, v108
    v_mul_f32 v153, v153, v109
    v_mul_f32 v138, v138, v108
    v_mul_f32 v154, v154, v109
    v_mul_f32 v139, v139, v108
    v_mul_f32 v155, v155, v109
    v_mul_f32 v140, v140, v108
    v_mul_f32 v156, v156, v109
    v_mul_f32 v141, v141, v108
    v_mul_f32 v157, v157, v109
    v_mul_f32 v142, v142, v108
    v_mul_f32 v158, v158, v109
    v_mul_f32 v143, v143, v108
    v_mul_f32 v159, v159, v109
    v_mul_f32 v144, v144, v108
    v_mul_f32 v160, v160, v109
    v_mul_f32 v145, v145, v108
    v_mul_f32 v161, v161, v109
    v_mul_f32 v146, v146, v108
    v_mul_f32 v162, v162, v109
    v_mul_f32 v147, v147, v108
    v_mul_f32 v163, v163, v109
    v_cvt_pk_bf16_f32 v88, v132, v133
    v_cvt_pk_bf16_f32 v96, v148, v149
    v_cvt_pk_bf16_f32 v89, v134, v135
    v_cvt_pk_bf16_f32 v97, v150, v151
    v_cvt_pk_bf16_f32 v90, v136, v137
    v_cvt_pk_bf16_f32 v98, v152, v153
    v_cvt_pk_bf16_f32 v91, v138, v139
    v_cvt_pk_bf16_f32 v99, v154, v155
    v_cvt_pk_bf16_f32 v92, v140, v141
    v_cvt_pk_bf16_f32 v100, v156, v157
    v_cvt_pk_bf16_f32 v93, v142, v143
    v_cvt_pk_bf16_f32 v101, v158, v159
    v_cvt_pk_bf16_f32 v94, v144, v145
    v_cvt_pk_bf16_f32 v102, v160, v161
    v_cvt_pk_bf16_f32 v95, v146, v147
    v_cvt_pk_bf16_f32 v103, v162, v163
    v_mfma_f32_32x32x16_bf16 v[132:147], v[88:91], v[248:251], 0
    v_mfma_f32_32x32x16_bf16 v[148:163], v[96:99], v[248:251], 0
    v_mfma_f32_32x32x16_bf16 v[132:147], v[92:95], v[252:255], v[132:147]
    v_mfma_f32_32x32x16_bf16 v[148:163], v[100:103], v[252:255], v[148:163]
    v_cvt_pk_bf16_f32 v212, v8, v9
    v_cvt_pk_bf16_f32 v213, v10, v11
    v_cvt_pk_bf16_f32 v214, v12, v13
    v_cvt_pk_bf16_f32 v215, v14, v15
    v_cvt_pk_bf16_f32 v216, v16, v17
    v_cvt_pk_bf16_f32 v217, v18, v19
    v_cvt_pk_bf16_f32 v218, v20, v21
    v_cvt_pk_bf16_f32 v219, v22, v23
    s_nop 2
    v_cvt_pk_bf16_f32 v72, v132, v133
    v_cvt_pk_bf16_f32 v73, v134, v135
    v_cvt_pk_bf16_f32 v74, v136, v137
    v_cvt_pk_bf16_f32 v75, v138, v139
    v_cvt_pk_bf16_f32 v76, v140, v141
    v_cvt_pk_bf16_f32 v77, v142, v143
    v_cvt_pk_bf16_f32 v78, v144, v145
    v_cvt_pk_bf16_f32 v79, v146, v147
    v_cvt_pk_bf16_f32 v80, v148, v149
    v_cvt_pk_bf16_f32 v81, v150, v151
    v_cvt_pk_bf16_f32 v82, v152, v153
    v_cvt_pk_bf16_f32 v83, v154, v155
    v_cvt_pk_bf16_f32 v84, v156, v157
    v_cvt_pk_bf16_f32 v85, v158, v159
    v_cvt_pk_bf16_f32 v86, v160, v161
    v_cvt_pk_bf16_f32 v87, v162, v163
    v_mfma_f32_32x32x16_bf16 v[164:179], v[72:75], v[64:67], 0
    v_mfma_f32_32x32x16_bf16 v[196:211], v[72:75], v[128:131], 0
    v_mfma_f32_32x32x16_bf16 v[180:195], v[80:83], v[64:67], 0
    v_mfma_f32_32x32x16_bf16 v[112:127], v[80:83], v[128:131], 0
    v_mfma_f32_32x32x16_bf16 v[164:179], v[76:79], v[68:71], v[164:179]
    v_mfma_f32_32x32x16_bf16 v[196:211], v[76:79], v[128:131], v[196:211]
    v_mfma_f32_32x32x16_bf16 v[180:195], v[84:87], v[68:71], v[180:195]
    v_mfma_f32_32x32x16_bf16 v[112:127], v[84:87], v[128:131], v[112:127]
    s_barrier
    s_lshl_b32 s46, s33, 13
    v_add_u32 v7, s46, v3
    s_nop 5
    ds_write_b128 v7, v[164:167] offset:0
    ds_write_b128 v7, v[168:171] offset:1024
    ds_write_b128 v7, v[172:175] offset:2048
    ds_write_b128 v7, v[176:179] offset:3072
    ds_write_b128 v7, v[180:183] offset:4096
    ds_write_b128 v7, v[184:187] offset:5120
    ds_write_b128 v7, v[188:191] offset:6144
    ds_write_b128 v7, v[192:195] offset:7168
    s_lshl_b32 s46, s33, 8
    s_add_u32 s46, s46, 65536
    v_lshlrev_b32 v7, 4, v6
    v_add_u32 v7, s46, v7
    s_mov_b32 exec_lo, 1
    s_mov_b32 exec_hi, 1
    ds_write_b128 v7, v[196:199] offset:0
    ds_write_b128 v7, v[200:203] offset:32
    ds_write_b128 v7, v[204:207] offset:64
    ds_write_b128 v7, v[208:211] offset:96
    ds_write_b128 v7, v[112:115] offset:128
    ds_write_b128 v7, v[116:119] offset:160
    ds_write_b128 v7, v[120:123] offset:192
    ds_write_b128 v7, v[124:127] offset:224
    s_mov_b64 exec, -1
    s_cmp_lg_u32 s33, 0
    s_cbranch_scc1 Lpb45
    s_lshl_b32 s42, s34, 8
    s_lshl_b32 s43, s35, 3
    s_add_u32 s42, s42, s43
    s_add_u32 s42, s42, 48250880
    s_lshl_b32 s43, s32, 11
    s_add_u32 s42, s42, s43
    v_mov_b32 v230, s42
    v_mov_b32 v232, s6
    v_mov_b32 v233, s7
    s_mov_b64 exec, 1
    s_cmp_eq_u32 s36, 0
    s_cbranch_scc1 Lst46
    buffer_store_dwordx2 v[232:233], v230, s[8:11], 0 offen
    s_branch Lsd47
Lst46:
    buffer_store_dwordx2 v[232:233], v230, s[8:11], 0 offen sc1
Lsd47:
    s_mov_b64 exec, -1
Lpb45:
    s_waitcnt lgkmcnt(0)
    s_barrier
    s_lshl_b32 s46, s33, 10
    v_add_u32 v7, s46, v3
    ds_read_b128 v[164:167], v7 offset:0
    ds_read_b128 v[168:171], v7 offset:8192
    ds_read_b128 v[172:175], v7 offset:16384
    ds_read_b128 v[176:179], v7 offset:24576
    ds_read_b128 v[180:183], v7 offset:32768
    ds_read_b128 v[184:187], v7 offset:40960
    ds_read_b128 v[188:191], v7 offset:49152
    ds_read_b128 v[192:195], v7 offset:57344
    v_and_b32 v9, 15, v1
    v_lshrrev_b32 v10, 1, v9
    v_lshlrev_b32 v10, 8, v10
    v_and_b32 v11, 1, v9
    v_lshl_add_u32 v10, v11, 4, v10
    s_lshl_b32 s46, s33, 5
    s_add_u32 s46, s46, 65536
    v_add_u32 v10, s46, v10
    ds_read_b128 v[196:199], v10
    s_mul_i32 s49, s32, 2162688
    s_lshl_b32 s47, s35, 3
    s_add_u32 s47, s47, s34
    s_mul_i32 s47, s47, 8448
    s_add_u32 s47, s47, s49
    s_add_u32 s47, s47, 42991616
    v_add_u32 v8, s47, v7
    s_waitcnt lgkmcnt(0)
    v_add_f32 v164, v164, v168
    v_add_f32 v172, v172, v176
    v_add_f32 v180, v180, v184
    v_add_f32 v188, v188, v192
    v_add_f32 v165, v165, v169
    v_add_f32 v173, v173, v177
    v_add_f32 v181, v181, v185
    v_add_f32 v189, v189, v193
    v_add_f32 v166, v166, v170
    v_add_f32 v174, v174, v178
    v_add_f32 v182, v182, v186
    v_add_f32 v190, v190, v194
    v_add_f32 v167, v167, v171
    v_add_f32 v175, v175, v179
    v_add_f32 v183, v183, v187
    v_add_f32 v191, v191, v195
    v_add_f32 v164, v164, v172
    v_add_f32 v180, v180, v188
    v_add_f32 v165, v165, v173
    v_add_f32 v181, v181, v189
    v_add_f32 v166, v166, v174
    v_add_f32 v182, v182, v190
    v_add_f32 v167, v167, v175
    v_add_f32 v183, v183, v191
    v_add_f32 v164, v164, v180
    v_add_f32 v165, v165, v181
    v_add_f32 v166, v166, v182
    v_add_f32 v167, v167, v183
    v_cvt_pk_bf16_f32 v164, v164, v165
    v_cvt_pk_bf16_f32 v165, v166, v167
    v_mov_b32 v166, s6
    v_mov_b32 v167, s7
    buffer_store_dwordx4 v[164:167], v8, s[8:11], 0 offen sc1
    v_add_f32_dpp v196, v196, v196 quad_perm:[2,3,0,1] row_mask:0xf bank_mask:0xf
    v_add_f32_dpp v197, v197, v197 quad_perm:[2,3,0,1] row_mask:0xf bank_mask:0xf
    v_add_f32_dpp v198, v198, v198 quad_perm:[2,3,0,1] row_mask:0xf bank_mask:0xf
    v_add_f32_dpp v199, v199, v199 quad_perm:[2,3,0,1] row_mask:0xf bank_mask:0xf
    v_add_f32_dpp v196, v196, v196 row_ror:4 row_mask:0xf bank_mask:0xf
    v_add_f32_dpp v197, v197, v197 row_ror:4 row_mask:0xf bank_mask:0xf
    v_add_f32_dpp v198, v198, v198 row_ror:4 row_mask:0xf bank_mask:0xf
    v_add_f32_dpp v199, v199, v199 row_ror:4 row_mask:0xf bank_mask:0xf
    v_add_f32_dpp v196, v196, v196 row_ror:8 row_mask:0xf bank_mask:0xf
    v_add_f32_dpp v197, v197, v197 row_ror:8 row_mask:0xf bank_mask:0xf
    v_add_f32_dpp v198, v198, v198 row_ror:8 row_mask:0xf bank_mask:0xf
    v_add_f32_dpp v199, v199, v199 row_ror:8 row_mask:0xf bank_mask:0xf
    v_cvt_pk_bf16_f32 v196, v196, v197
    v_cvt_pk_bf16_f32 v197, v198, v199
    v_mov_b32 v198, s6
    v_mov_b32 v199, s7
    s_lshl_b32 s46, s33, 5
    s_add_u32 s46, s46, s47
    s_add_u32 s46, s46, 8192
    v_lshl_add_u32 v9, v11, 4, s46
    s_mov_b64 exec, 3
    buffer_store_dwordx4 v[196:199], v9, s[8:11], 0 offen sc1
    s_mov_b64 exec, -1
    v_mfma_f32_32x32x16_bf16 v[72:87], v[240:243], v[212:215], 0
    v_mfma_f32_32x32x16_bf16 v[72:87], v[244:247], v[216:219], v[72:87]
    s_nop 11
    v_max3_f32 v104, v72, v73, v74
    v_min3_f32 v105, v72, v73, v74
    v_max3_f32 v104, v104, v75, v76
    v_min3_f32 v105, v105, v75, v76
    v_max3_f32 v104, v104, v77, v78
    v_min3_f32 v105, v105, v77, v78
    v_max3_f32 v104, v104, v79, v80
    v_min3_f32 v105, v105, v79, v80
    v_max3_f32 v104, v104, v81, v82
    v_min3_f32 v105, v105, v81, v82
    v_max3_f32 v104, v104, v83, v84
    v_min3_f32 v105, v105, v83, v84
    v_max3_f32 v104, v104, v85, v86
    v_min3_f32 v105, v105, v85, v86
    v_max_f32 v104, v104, v87
    v_min_f32 v105, v105, v87
    v_mov_b32 v106, v104
    v_mov_b32 v107, v105
    s_nop 0
    v_permlane32_swap_b32 v104, v106
    v_permlane32_swap_b32 v105, v107
    v_max_f32 v104, v104, v106
    v_min_f32 v105, v105, v107
    v_mul_f32 v106, s41, v104
    v_mul_f32 v110, s40, v105
    v_mul_f32 v107, s41, v104
    v_mul_f32 v111, s40, v105
    v_pk_fma_f32 v[132:133], v[72:73], s[24:25], v[106:107]
    v_pk_fma_f32 v[148:149], v[72:73], s[26:27], v[110:111]
    v_pk_fma_f32 v[134:135], v[74:75], s[24:25], v[106:107]
    v_pk_fma_f32 v[150:151], v[74:75], s[26:27], v[110:111]
    v_pk_fma_f32 v[136:137], v[76:77], s[24:25], v[106:107]
    v_pk_fma_f32 v[152:153], v[76:77], s[26:27], v[110:111]
    v_pk_fma_f32 v[138:139], v[78:79], s[24:25], v[106:107]
    v_pk_fma_f32 v[154:155], v[78:79], s[26:27], v[110:111]
    v_pk_fma_f32 v[140:141], v[80:81], s[24:25], v[106:107]
    v_pk_fma_f32 v[156:157], v[80:81], s[26:27], v[110:111]
    v_pk_fma_f32 v[142:143], v[82:83], s[24:25], v[106:107]
    v_pk_fma_f32 v[158:159], v[82:83], s[26:27], v[110:111]
    v_pk_fma_f32 v[144:145], v[84:85], s[24:25], v[106:107]
    v_pk_fma_f32 v[160:161], v[84:85], s[26:27], v[110:111]
    v_pk_fma_f32 v[146:147], v[86:87], s[24:25], v[106:107]
    v_pk_fma_f32 v[162:163], v[86:87], s[26:27], v[110:111]
    v_exp_f32 v132, v132
    v_exp_f32 v148, v148
    v_exp_f32 v133, v133
    v_exp_f32 v149, v149
    v_exp_f32 v134, v134
    v_exp_f32 v150, v150
    v_exp_f32 v135, v135
    v_exp_f32 v151, v151
    v_exp_f32 v136, v136
    v_exp_f32 v152, v152
    v_exp_f32 v137, v137
    v_exp_f32 v153, v153
    v_exp_f32 v138, v138
    v_exp_f32 v154, v154
    v_exp_f32 v139, v139
    v_exp_f32 v155, v155
    v_exp_f32 v140, v140
    v_exp_f32 v156, v156
    v_exp_f32 v141, v141
    v_exp_f32 v157, v157
    v_exp_f32 v142, v142
    v_exp_f32 v158, v158
    v_exp_f32 v143, v143
    v_exp_f32 v159, v159
    v_exp_f32 v144, v144
    v_exp_f32 v160, v160
    v_exp_f32 v145, v145
    v_exp_f32 v161, v161
    v_exp_f32 v146, v146
    v_exp_f32 v162, v162
    v_exp_f32 v147, v147
    v_exp_f32 v163, v163
    v_add_f32 v108, v132, v133
    v_add_f32 v109, v148, v149
    v_add_f32 v110, v134, v135
    v_add_f32 v111, v150, v151
    v_add_f32 v108, v108, v136
    v_add_f32 v109, v109, v152
    v_add_f32 v110, v110, v137
    v_add_f32 v111, v111, v153
    v_add_f32 v108, v108, v138
    v_add_f32 v109, v109, v154
    v_add_f32 v110, v110, v139
    v_add_f32 v111, v111, v155
    v_add_f32 v108, v108, v140
    v_add_f32 v109, v109, v156
    v_add_f32 v110, v110, v141
    v_add_f32 v111, v111, v157
    v_add_f32 v108, v108, v142
    v_add_f32 v109, v109, v158
    v_add_f32 v110, v110, v143
    v_add_f32 v111, v111, v159
    v_add_f32 v108, v108, v144
    v_add_f32 v109, v109, v160
    v_add_f32 v110, v110, v145
    v_add_f32 v111, v111, v161
    v_add_f32 v108, v108, v146
    v_add_f32 v109, v109, v162
    v_add_f32 v110, v110, v147
    v_add_f32 v111, v111, v163
    v_add_f32 v108, v108, v110
    v_add_f32 v109, v109, v111
    v_mov_b32 v106, v108
    v_mov_b32 v107, v109
    s_nop 0
    v_permlane32_swap_b32 v108, v106
    v_permlane32_swap_b32 v109, v107
    v_add_f32 v108, v108, v106
    v_add_f32 v109, v109, v107
    v_rcp_f32 v109, v109
    v_cvt_pk_bf16_f32 v88, v132, v133
    v_cvt_pk_bf16_f32 v89, v134, v135
    v_cvt_pk_bf16_f32 v90, v136, v137
    v_cvt_pk_bf16_f32 v91, v138, v139
    v_cvt_pk_bf16_f32 v92, v140, v141
    v_cvt_pk_bf16_f32 v93, v142, v143
    v_cvt_pk_bf16_f32 v94, v144, v145
    v_cvt_pk_bf16_f32 v95, v146, v147
    v_mul_f32 v109, v109, v108
    v_mul_f32 v148, v148, v109
    v_mul_f32 v149, v149, v109
    v_mul_f32 v150, v150, v109
    v_mul_f32 v151, v151, v109
    v_mul_f32 v152, v152, v109
    v_mul_f32 v153, v153, v109
    v_mul_f32 v154, v154, v109
    v_mul_f32 v155, v155, v109
    v_mul_f32 v156, v156, v109
    v_mul_f32 v157, v157, v109
    v_mul_f32 v158, v158, v109
    v_mul_f32 v159, v159, v109
    v_mul_f32 v160, v160, v109
    v_mul_f32 v161, v161, v109
    v_mul_f32 v162, v162, v109
    v_mul_f32 v163, v163, v109
    v_cvt_pk_bf16_f32 v96, v148, v149
    v_cvt_pk_bf16_f32 v97, v150, v151
    v_cvt_pk_bf16_f32 v98, v152, v153
    v_cvt_pk_bf16_f32 v99, v154, v155
    v_cvt_pk_bf16_f32 v100, v156, v157
    v_cvt_pk_bf16_f32 v101, v158, v159
    v_cvt_pk_bf16_f32 v102, v160, v161
    v_cvt_pk_bf16_f32 v103, v162, v163
    v_mul_f32 v211, 0x358637bd, v108
    s_barrier
    s_mul_i32 s47, s35, 67584
    s_mul_i32 s49, s32, 2162688
    s_add_u32 s47, s47, s49
    s_add_u32 s47, s47, 42991616
    v_add_u32 v8, s47, v7
    v_and_b32 v9, 15, v1
    v_lshrrev_b32 v10, 1, v9
    v_mul_u32_u24 v10, 8448, v10
    v_and_b32 v11, 1, v9
    v_lshl_add_u32 v10, v11, 4, v10
    s_lshl_b32 s46, s33, 5
    s_add_u32 s46, s46, s47
    s_add_u32 s46, s46, 8192
    v_add_u32 v10, s46, v10
    s_mov_b32 s50, 0
    v_and_b32 v206, 31, v1
    s_lshl_b32 s46, s34, 8
    s_lshl_b32 s48, s32, 11
    s_add_u32 s46, s46, s48
    s_add_u32 s46, s46, 48250880
    v_lshl_add_u32 v206, v206, 3, s46
Lga48:
    s_mov_b32 s51, 0
    buffer_load_dwordx4 v[164:167], v8, s[8:11], s51 offen sc1
    s_mov_b32 s51, 8448
    buffer_load_dwordx4 v[168:171], v8, s[8:11], s51 offen sc1
    s_mov_b32 s51, 16896
    buffer_load_dwordx4 v[172:175], v8, s[8:11], s51 offen sc1
    s_mov_b32 s51, 25344
    buffer_load_dwordx4 v[176:179], v8, s[8:11], s51 offen sc1
    s_mov_b32 s51, 33792
    buffer_load_dwordx4 v[180:183], v8, s[8:11], s51 offen sc1
    s_mov_b32 s51, 42240
    buffer_load_dwordx4 v[184:187], v8, s[8:11], s51 offen sc1
    s_mov_b32 s51, 50688
    buffer_load_dwordx4 v[188:191], v8, s[8:11], s51 offen sc1
    s_mov_b32 s51, 59136
    buffer_load_dwordx4 v[192:195], v8, s[8:11], s51 offen sc1
    buffer_load_dwordx4 v[196:199], v10, s[8:11], 0 offen sc1
    buffer_load_dwordx2 v[204:205], v206, s[8:11], 0 offen sc1
    s_add_u32 s50, s50, 1
    s_cmp_gt_u32 s50, 500000
    s_cbranch_scc1 Lgg49
    s_waitcnt vmcnt(0)
    v_xor_b32 v132, s6, v198
    v_xor_b32 v133, s7, v199
    v_xor_b32 v134, s6, v204
    v_xor_b32 v135, s7, v205
    v_or3_b32 v132, v132, v134, v135
    v_xor_b32 v134, s6, v166
    v_xor_b32 v135, s7, v167
    v_or3_b32 v132, v132, v134, v135
    v_xor_b32 v134, s6, v170
    v_xor_b32 v135, s7, v171
    v_or3_b32 v133, v133, v134, v135
    v_xor_b32 v134, s6, v174
    v_xor_b32 v135, s7, v175
    v_or3_b32 v132, v132, v134, v135
    v_xor_b32 v134, s6, v178
    v_xor_b32 v135, s7, v179
    v_or3_b32 v133, v133, v134, v135
    v_xor_b32 v134, s6, v182
    v_xor_b32 v135, s7, v183
    v_or3_b32 v132, v132, v134, v135
    v_xor_b32 v134, s6, v186
    v_xor_b32 v135, s7, v187
    v_or3_b32 v133, v133, v134, v135
    v_xor_b32 v134, s6, v190
    v_xor_b32 v135, s7, v191
    v_or3_b32 v132, v132, v134, v135
    v_xor_b32 v134, s6, v194
    v_xor_b32 v135, s7, v195
    v_or3_b32 v133, v133, v134, v135
    v_or_b32 v132, v132, v133
    v_cmp_ne_u32 vcc, 0, v132
    s_cbranch_vccnz Lga48
Lgg49:
    s_waitcnt vmcnt(0)
    s_add_u32 m0, s61, 0
    s_mov_b32 s44, 18907136
    buffer_load_dwordx4 v237, s[8:11], s44 offen offset:0  lds
    buffer_load_dwordx4 v237, s[8:11], s44 offen offset:1024  lds
    buffer_load_dwordx4 v237, s[8:11], s44 offen offset:2048  lds
    buffer_load_dwordx4 v237, s[8:11], s44 offen offset:3072  lds
    s_add_u32 m0, s61, 32768
    s_mov_b32 s44, 18923520
    buffer_load_dwordx4 v237, s[8:11], s44 offen offset:0  lds
    buffer_load_dwordx4 v237, s[8:11], s44 offen offset:1024  lds
    buffer_load_dwordx4 v237, s[8:11], s44 offen offset:2048  lds
    buffer_load_dwordx4 v237, s[8:11], s44 offen offset:3072  lds
    v_lshlrev_b32 v132, 16, v164
    v_and_b32 v133, s39, v164
    v_lshlrev_b32 v134, 16, v165
    v_and_b32 v135, s39, v165
    v_lshlrev_b32 v136, 16, v168
    v_and_b32 v137, s39, v168
    v_lshlrev_b32 v138, 16, v169
    v_and_b32 v139, s39, v169
    v_lshlrev_b32 v140, 16, v172
    v_and_b32 v141, s39, v172
    v_lshlrev_b32 v142, 16, v173
    v_and_b32 v143, s39, v173
    v_lshlrev_b32 v144, 16, v176
    v_and_b32 v145, s39, v176
    v_lshlrev_b32 v146, 16, v177
    v_and_b32 v147, s39, v177
    v_lshlrev_b32 v148, 16, v180
    v_and_b32 v149, s39, v180
    v_lshlrev_b32 v150, 16, v181
    v_and_b32 v151, s39, v181
    v_lshlrev_b32 v152, 16, v184
    v_and_b32 v153, s39, v184
    v_lshlrev_b32 v154, 16, v185
    v_and_b32 v155, s39, v185
    v_lshlrev_b32 v156, 16, v188
    v_and_b32 v157, s39, v188
    v_lshlrev_b32 v158, 16, v189
    v_and_b32 v159, s39, v189
    v_lshlrev_b32 v160, 16, v192
    v_and_b32 v161, s39, v192
    v_lshlrev_b32 v162, 16, v193
    v_and_b32 v163, s39, v193
    v_lshlrev_b32 v200, 16, v196
    v_and_b32 v201, s39, v196
    v_lshlrev_b32 v202, 16, v197
    v_and_b32 v203, s39, v197
    v_add_f32 v132, v132, v136
    v_add_f32 v140, v140, v144
    v_add_f32 v148, v148, v152
    v_add_f32 v156, v156, v160
    v_add_f32 v133, v133, v137
    v_add_f32 v141, v141, v145
    v_add_f32 v149, v149, v153
    v_add_f32 v157, v157, v161
    v_add_f32 v134, v134, v138
    v_add_f32 v142, v142, v146
    v_add_f32 v150, v150, v154
    v_add_f32 v158, v158, v162
    v_add_f32 v135, v135, v139
    v_add_f32 v143, v143, v147
    v_add_f32 v151, v151, v155
    v_add_f32 v159, v159, v163
    v_add_f32 v132, v132, v140
    v_add_f32 v148, v148, v156
    v_add_f32 v133, v133, v141
    v_add_f32 v149, v149, v157
    v_add_f32 v134, v134, v142
    v_add_f32 v150, v150, v158
    v_add_f32 v135, v135, v143
    v_add_f32 v151, v151, v159
    v_add_f32 v132, v132, v148
    v_add_f32 v133, v133, v149
    v_add_f32 v134, v134, v150
    v_add_f32 v135, v135, v151
    v_add_f32_dpp v200, v200, v200 quad_perm:[2,3,0,1] row_mask:0xf bank_mask:0xf
    v_add_f32_dpp v201, v201, v201 quad_perm:[2,3,0,1] row_mask:0xf bank_mask:0xf
    v_add_f32_dpp v202, v202, v202 quad_perm:[2,3,0,1] row_mask:0xf bank_mask:0xf
    v_add_f32_dpp v203, v203, v203 quad_perm:[2,3,0,1] row_mask:0xf bank_mask:0xf
    v_add_f32_dpp v200, v200, v200 row_ror:4 row_mask:0xf bank_mask:0xf
    v_add_f32_dpp v201, v201, v201 row_ror:4 row_mask:0xf bank_mask:0xf
    v_add_f32_dpp v202, v202, v202 row_ror:4 row_mask:0xf bank_mask:0xf
    v_add_f32_dpp v203, v203, v203 row_ror:4 row_mask:0xf bank_mask:0xf
    v_add_f32_dpp v200, v200, v200 row_ror:8 row_mask:0xf bank_mask:0xf
    v_add_f32_dpp v201, v201, v201 row_ror:8 row_mask:0xf bank_mask:0xf
    v_add_f32_dpp v202, v202, v202 row_ror:8 row_mask:0xf bank_mask:0xf
    v_add_f32_dpp v203, v203, v203 row_ror:8 row_mask:0xf bank_mask:0xf
    v_cvt_pk_bf16_f32 v164, v132, v133
    v_cvt_pk_bf16_f32 v165, v134, v135
    v_cvt_pk_bf16_f32 v166, v200, v201
    v_cvt_pk_bf16_f32 v167, v202, v203
    s_lshr_b32 s46, s33, 1
    s_lshl_b32 s47, s46, 10
    s_and_b32 s48, s33, 1
    s_lshl_b32 s48, s48, 3
    s_add_u32 s47, s47, s48
    s_add_u32 s47, s47, 67584
    v_add_u32 v9, s47, v3
    ds_write_b64 v9, v[164:165]
    s_lshl_b32 s46, s46, 5
    s_add_u32 s46, s46, s48
    s_add_u32 s46, s46, 71680
    v_lshl_add_u32 v9, v11, 4, s46
    s_mov_b64 exec, 3
    ds_write_b64 v9, v[166:167]
    s_mov_b64 exec, -1
    s_waitcnt lgkmcnt(0)
    s_barrier
    v_lshlrev_b32 v10, 4, v6
    v_add_u32 v10, 71680, v10
    v_add_u32 v11, 67584, v3
    ds_read_b128 v[132:135], v11 offset:0
    ds_read_b128 v[148:151], v10 offset:0
    ds_read_b128 v[136:139], v11 offset:1024
    ds_read_b128 v[152:155], v10 offset:32
    ds_read_b128 v[140:143], v11 offset:2048
    ds_read_b128 v[156:159], v10 offset:64
    ds_read_b128 v[144:147], v11 offset:3072
    ds_read_b128 v[160:163], v10 offset:96
    s_waitcnt lgkmcnt(0)
    v_mfma_f32_32x32x16_bf16 v[164:179], v[132:135], v[88:91], 0
    v_mfma_f32_32x32x16_bf16 v[180:195], v[148:151], v[88:91], 0
    v_mfma_f32_32x32x16_bf16 v[164:179], v[136:139], v[92:95], v[164:179]
    v_mfma_f32_32x32x16_bf16 v[180:195], v[152:155], v[92:95], v[180:195]
    v_mfma_f32_32x32x16_bf16 v[164:179], v[140:143], v[96:99], v[164:179]
    v_mfma_f32_32x32x16_bf16 v[180:195], v[156:159], v[96:99], v[180:195]
    v_mfma_f32_32x32x16_bf16 v[164:179], v[144:147], v[100:103], v[164:179]
    v_mfma_f32_32x32x16_bf16 v[180:195], v[160:163], v[100:103], v[180:195]
    s_nop 11
    v_add_f32 v9, v211, v180
    v_rcp_f32 v9, v9
    s_nop 0
    v_mul_f32 v164, v164, v9
    v_mul_f32 v165, v165, v9
    v_mul_f32 v166, v166, v9
    v_mul_f32 v167, v167, v9
    v_mul_f32 v168, v168, v9
    v_mul_f32 v169, v169, v9
    v_mul_f32 v170, v170, v9
    v_mul_f32 v171, v171, v9
    v_mul_f32 v172, v172, v9
    v_mul_f32 v173, v173, v9
    v_mul_f32 v174, v174, v9
    v_mul_f32 v175, v175, v9
    v_mul_f32 v176, v176, v9
    v_mul_f32 v177, v177, v9
    v_mul_f32 v178, v178, v9
    v_mul_f32 v179, v179, v9
    v_cvt_pk_bf16_f32 v56, v164, v165
    v_cvt_pk_bf16_f32 v57, v166, v167
    v_cvt_pk_bf16_f32 v58, v168, v169
    v_cvt_pk_bf16_f32 v59, v170, v171
    v_cvt_pk_bf16_f32 v60, v172, v173
    v_cvt_pk_bf16_f32 v61, v174, v175
    v_cvt_pk_bf16_f32 v62, v176, v177
    v_cvt_pk_bf16_f32 v63, v178, v179
    v_permlane32_swap_b32 v56, v58
    v_permlane32_swap_b32 v57, v59
    v_permlane32_swap_b32 v60, v62
    v_permlane32_swap_b32 v61, v63
    s_mul_i32 s46, s35, 24576
    v_add_u32 v9, s46, v2
    s_cmp_eq_u32 s36, 0
    s_cbranch_scc1 Lst50
    s_mov_b32 s46, 0
    s_mov_b32 s47, 12288
    buffer_store_dwordx4 v[56:59], v9, s[8:11], s46 offen
    buffer_store_dwordx4 v[60:63], v9, s[8:11], s47 offen
    s_branch Lsd51
Lst50:
    s_mov_b32 s46, 0
    s_mov_b32 s47, 12288
    buffer_store_dwordx4 v[56:59], v9, s[8:11], s46 offen sc1
    buffer_store_dwordx4 v[60:63], v9, s[8:11], s47 offen sc1
Lsd51:
    s_waitcnt vmcnt(0)
    s_barrier
    s_cmp_lg_u32 s33, 0
    s_cbranch_scc1 Lpb52
    s_lshl_b32 s42, s34, 8
    s_lshl_b32 s43, s35, 3
    s_add_u32 s42, s42, s43
    s_add_u32 s42, s42, 48242688
    s_lshl_b32 s43, s32, 11
    s_add_u32 s42, s42, s43
    v_mov_b32 v230, s42
    v_mov_b32 v232, s6
    v_mov_b32 v233, s7
    s_mov_b64 exec, 1
    s_cmp_eq_u32 s36, 0
    s_cbranch_scc1 Lst53
    buffer_store_dwordx2 v[232:233], v230, s[8:11], 0 offen
    s_branch Lsd54
Lst53:
    buffer_store_dwordx2 v[232:233], v230, s[8:11], 0 offen sc1
Lsd54:
    s_mov_b64 exec, -1
Lpb52:
    v_and_b32 v1, 63, v0
    v_and_b32 v5, 31, v1
    v_lshrrev_b32 v6, 5, v1
    s_and_b32 s42, s35, 1
    s_lshl_b32 s43, s34, 1
    s_add_u32 s42, s42, s43
    s_lshl_b32 s42, s42, 7
    s_lshl_b32 s43, s59, 5
    s_add_u32 s42, s42, s43
    v_add_u32 v7, s42, v5
    v_mul_u32_u24 v8, 6144, v6
    v_and_b32 v12, 255, v7
    v_lshl_add_u32 v8, v12, 4, v8
    s_mul_i32 s44, s34, 786432
    v_add_u32 v8, s44, v8
    s_mul_i32 s42, s60, 393216
    v_add_u32 v2, s42, v8
    v_lshlrev_b32 v3, 4, v1
    s_lshl_b32 s43, s60, 14
    s_lshl_b32 s44, s60, 10
    s_add_u32 s45, s43, s44
    v_add_u32 v9, s45, v3
    s_sub_u32 s45, s43, s44
    s_add_u32 s45, s45, 1024
    v_add_u32 v10, s45, v3
    v_add_u32 v13, 73728, v9
    v_add_u32 v14, 73728, v10
    s_lshl_b32 s50, s58, 3
    s_lshl_b32 s51, s60, 2
    s_add_u32 s50, s50, s51
    s_mul_i32 s50, s50, 6144
    v_add_u32 v11, s50, v8
    v_mul_u32_u24 v12, 6144, v6
    v_sub_u32 v12, v11, v12
    v_lshl_add_u32 v12, v6, 3, v12
    s_mov_b32 s42, 28311552
    buffer_load_dwordx2 v[112:113], v12, s[8:11], s42 offen sc1
    s_mov_b32 s42, 28317696
    buffer_load_dwordx2 v[114:115], v12, s[8:11], s42 offen sc1
    s_mov_b32 s42, 28323840
    buffer_load_dwordx2 v[116:117], v12, s[8:11], s42 offen sc1
    s_mov_b32 s42, 28329984
    buffer_load_dwordx2 v[118:119], v12, s[8:11], s42 offen sc1
    v_mov_b32 v16, 0
    v_mov_b32 v17, 0
    v_mov_b32 v18, 0
    v_mov_b32 v19, 0
    v_mov_b32 v20, 0
    v_mov_b32 v21, 0
    v_mov_b32 v22, 0
    v_mov_b32 v23, 0
    v_mov_b32 v24, 0
    v_mov_b32 v25, 0
    v_mov_b32 v26, 0
    v_mov_b32 v27, 0
    v_mov_b32 v28, 0
    v_mov_b32 v29, 0
    v_mov_b32 v30, 0
    v_mov_b32 v31, 0
    v_mov_b32 v32, 0
    v_mov_b32 v33, 0
    v_mov_b32 v34, 0
    v_mov_b32 v35, 0
    v_mov_b32 v36, 0
    v_mov_b32 v37, 0
    v_mov_b32 v38, 0
    v_mov_b32 v39, 0
    v_mov_b32 v40, 0
    v_mov_b32 v41, 0
    v_mov_b32 v42, 0
    v_mov_b32 v43, 0
    v_mov_b32 v44, 0
    v_mov_b32 v45, 0
    v_mov_b32 v46, 0
    v_mov_b32 v47, 0
    s_cmp_lg_u32 s33, 0
    s_cbranch_scc1 Lwo55
    v_and_b32 v200, 63, v0
    v_and_b32 v200, 31, v200
    v_lshlrev_b32 v200, 3, v200
    s_lshl_b32 s42, s34, 8
    s_add_u32 s42, s42, 48242688
    s_lshl_b32 s43, s32, 11
    s_add_u32 s42, s42, s43
    v_add_u32 v200, s42, v200
    s_mov_b32 s43, 0
Lpl58:
    buffer_load_dwordx2 v[202:203], v200, s[8:11], 0 offen sc1
    s_add_u32 s43, s43, 1
    s_cmp_gt_u32 s43, 500000
    s_cbranch_scc1 Lwf57
    s_waitcnt vmcnt(0)
    v_and_b32 v201, -16, v202
    v_xor_b32 v201, s6, v201
    v_xor_b32 v204, s7, v203
    v_or_b32 v201, v201, v204
    v_cmp_ne_u32 vcc, 0, v201
    s_cbranch_vccnz Lpl58
Lwf57:
    s_waitcnt vmcnt(0)
Lwo55:
    s_barrier
    s_mov_b32 s49, 0
    buffer_load_dwordx4 v[48:51], v2, s[8:11], s49 offen sc1
    s_mov_b32 s49, 12288
    buffer_load_dwordx4 v[52:55], v2, s[8:11], s49 offen sc1
    s_mov_b32 s49, 24576
    buffer_load_dwordx4 v[56:59], v2, s[8:11], s49 offen sc1
    s_mov_b32 s49, 36864
    buffer_load_dwordx4 v[60:63], v2, s[8:11], s49 offen sc1
    s_mov_b32 s49, 49152
    buffer_load_dwordx4 v[64:67], v2, s[8:11], s49 offen sc1
    s_mov_b32 s49, 61440
    buffer_load_dwordx4 v[68:71], v2, s[8:11], s49 offen sc1
    ds_read_b128 v[120:123], v13 offset:0
    ds_read_b128 v[124:127], v14 offset:0
    ds_read_b128 v[128:131], v13 offset:2048
    ds_read_b128 v[132:135], v14 offset:2048
    s_waitcnt lgkmcnt(2)
    s_waitcnt vmcnt(5)
    v_mfma_f32_32x32x16_bf16 v[16:31], v[120:123], v[48:51], v[16:31]
    v_mfma_f32_32x32x16_bf16 v[32:47], v[124:127], v[48:51], v[32:47]
    s_mov_b32 s49, 73728
    buffer_load_dwordx4 v[72:75], v2, s[8:11], s49 offen sc1
    s_mov_b32 s49, 86016
    buffer_load_dwordx4 v[76:79], v2, s[8:11], s49 offen sc1
    s_mov_b32 s49, 98304
    buffer_load_dwordx4 v[80:83], v2, s[8:11], s49 offen sc1
    ds_read_b128 v[120:123], v13 offset:4096
    ds_read_b128 v[124:127], v14 offset:4096
    s_waitcnt lgkmcnt(2)
    s_waitcnt vmcnt(7)
    v_mfma_f32_32x32x16_bf16 v[16:31], v[128:131], v[52:55], v[16:31]
    v_mfma_f32_32x32x16_bf16 v[32:47], v[132:135], v[52:55], v[32:47]
    s_mov_b32 s49, 110592
    buffer_load_dwordx4 v[84:87], v2, s[8:11], s49 offen sc1
    s_mov_b32 s49, 122880
    buffer_load_dwordx4 v[88:91], v2, s[8:11], s49 offen sc1
    s_mov_b32 s49, 135168
    buffer_load_dwordx4 v[92:95], v2, s[8:11], s49 offen sc1
    ds_read_b128 v[128:131], v13 offset:6144
    ds_read_b128 v[132:135], v14 offset:6144
    s_waitcnt lgkmcnt(2)
    s_waitcnt vmcnt(9)
    v_mfma_f32_32x32x16_bf16 v[16:31], v[120:123], v[56:59], v[16:31]
    v_mfma_f32_32x32x16_bf16 v[32:47], v[124:127], v[56:59], v[32:47]
    s_mov_b32 s49, 147456
    buffer_load_dwordx4 v[96:99], v2, s[8:11], s49 offen sc1
    s_mov_b32 s49, 159744
    buffer_load_dwordx4 v[100:103], v2, s[8:11], s49 offen sc1
    s_mov_b32 s49, 172032
    buffer_load_dwordx4 v[104:107], v2, s[8:11], s49 offen sc1
    ds_read_b128 v[120:123], v13 offset:8192
    ds_read_b128 v[124:127], v14 offset:8192
    s_waitcnt lgkmcnt(2)
    s_waitcnt vmcnt(11)
    v_mfma_f32_32x32x16_bf16 v[16:31], v[128:131], v[60:63], v[16:31]
    v_mfma_f32_32x32x16_bf16 v[32:47], v[132:135], v[60:63], v[32:47]
    s_mov_b32 s49, 184320
    buffer_load_dwordx4 v[108:111], v2, s[8:11], s49 offen sc1
    s_mov_b32 s49, 196608
    buffer_load_dwordx4 v[48:51], v2, s[8:11], s49 offen sc1
    s_mov_b32 s49, 208896
    buffer_load_dwordx4 v[52:55], v2, s[8:11], s49 offen sc1
    ds_read_b128 v[128:131], v13 offset:10240
    ds_read_b128 v[132:135], v14 offset:10240
    s_waitcnt lgkmcnt(2)
    s_waitcnt vmcnt(13)
    v_mfma_f32_32x32x16_bf16 v[16:31], v[120:123], v[64:67], v[16:31]
    v_mfma_f32_32x32x16_bf16 v[32:47], v[124:127], v[64:67], v[32:47]
    s_mov_b32 s49, 221184
    buffer_load_dwordx4 v[56:59], v2, s[8:11], s49 offen sc1
    s_mov_b32 s49, 233472
    buffer_load_dwordx4 v[60:63], v2, s[8:11], s49 offen sc1
    s_mov_b32 s49, 245760
    buffer_load_dwordx4 v[64:67], v2, s[8:11], s49 offen sc1
    ds_read_b128 v[120:123], v13 offset:12288
    ds_read_b128 v[124:127], v14 offset:12288
    s_waitcnt lgkmcnt(2)
    s_waitcnt vmcnt(15)
    v_mfma_f32_32x32x16_bf16 v[16:31], v[128:131], v[68:71], v[16:31]
    v_mfma_f32_32x32x16_bf16 v[32:47], v[132:135], v[68:71], v[32:47]
    s_mov_b32 s49, 258048
    buffer_load_dwordx4 v[68:71], v2, s[8:11], s49 offen sc1
    ds_read_b128 v[128:131], v13 offset:14336
    ds_read_b128 v[132:135], v14 offset:14336
    s_waitcnt lgkmcnt(2)
    s_waitcnt vmcnt(15)
    v_mfma_f32_32x32x16_bf16 v[16:31], v[120:123], v[72:75], v[16:31]
    v_mfma_f32_32x32x16_bf16 v[32:47], v[124:127], v[72:75], v[32:47]
    s_mov_b32 s49, 270336
    buffer_load_dwordx4 v[72:75], v2, s[8:11], s49 offen sc1
    ds_read_b128 v[120:123], v13 offset:32768
    ds_read_b128 v[124:127], v14 offset:32768
    s_waitcnt lgkmcnt(2)
    s_waitcnt vmcnt(15)
    v_mfma_f32_32x32x16_bf16 v[16:31], v[128:131], v[76:79], v[16:31]
    v_mfma_f32_32x32x16_bf16 v[32:47], v[132:135], v[76:79], v[32:47]
    s_mov_b32 s49, 282624
    buffer_load_dwordx4 v[76:79], v2, s[8:11], s49 offen sc1
    ds_read_b128 v[128:131], v13 offset:34816
    ds_read_b128 v[132:135], v14 offset:34816
    s_waitcnt lgkmcnt(2)
    s_waitcnt vmcnt(15)
    v_mfma_f32_32x32x16_bf16 v[16:31], v[120:123], v[80:83], v[16:31]
    v_mfma_f32_32x32x16_bf16 v[32:47], v[124:127], v[80:83], v[32:47]
    s_mov_b32 s49, 294912
    buffer_load_dwordx4 v[80:83], v2, s[8:11], s49 offen sc1
    ds_read_b128 v[120:123], v13 offset:36864
    ds_read_b128 v[124:127], v14 offset:36864
    s_waitcnt lgkmcnt(2)
    s_waitcnt vmcnt(15)
    v_mfma_f32_32x32x16_bf16 v[16:31], v[128:131], v[84:87], v[16:31]
    v_mfma_f32_32x32x16_bf16 v[32:47], v[132:135], v[84:87], v[32:47]
    s_mov_b32 s49, 307200
    buffer_load_dwordx4 v[84:87], v2, s[8:11], s49 offen sc1
    ds_read_b128 v[128:131], v13 offset:38912
    ds_read_b128 v[132:135], v14 offset:38912
    s_waitcnt lgkmcnt(2)
    s_waitcnt vmcnt(15)
    v_mfma_f32_32x32x16_bf16 v[16:31], v[120:123], v[88:91], v[16:31]
    v_mfma_f32_32x32x16_bf16 v[32:47], v[124:127], v[88:91], v[32:47]
    s_mov_b32 s49, 319488
    buffer_load_dwordx4 v[88:91], v2, s[8:11], s49 offen sc1
    ds_read_b128 v[120:123], v13 offset:40960
    ds_read_b128 v[124:127], v14 offset:40960
    s_waitcnt lgkmcnt(2)
    s_waitcnt vmcnt(15)
    v_mfma_f32_32x32x16_bf16 v[16:31], v[128:131], v[92:95], v[16:31]
    v_mfma_f32_32x32x16_bf16 v[32:47], v[132:135], v[92:95], v[32:47]
    s_mov_b32 s49, 331776
    buffer_load_dwordx4 v[92:95], v2, s[8:11], s49 offen sc1
    ds_read_b128 v[128:131], v13 offset:43008
    ds_read_b128 v[132:135], v14 offset:43008
    s_waitcnt lgkmcnt(2)
    s_waitcnt vmcnt(15)
    v_mfma_f32_32x32x16_bf16 v[16:31], v[120:123], v[96:99], v[16:31]
    v_mfma_f32_32x32x16_bf16 v[32:47], v[124:127], v[96:99], v[32:47]
    s_mov_b32 s49, 344064
    buffer_load_dwordx4 v[96:99], v2, s[8:11], s49 offen sc1
    ds_read_b128 v[120:123], v13 offset:45056
    ds_read_b128 v[124:127], v14 offset:45056
    s_waitcnt lgkmcnt(2)
    s_waitcnt vmcnt(15)
    v_mfma_f32_32x32x16_bf16 v[16:31], v[128:131], v[100:103], v[16:31]
    v_mfma_f32_32x32x16_bf16 v[32:47], v[132:135], v[100:103], v[32:47]
    s_mov_b32 s49, 356352
    buffer_load_dwordx4 v[100:103], v2, s[8:11], s49 offen sc1
    ds_read_b128 v[128:131], v13 offset:47104
    ds_read_b128 v[132:135], v14 offset:47104
    s_waitcnt lgkmcnt(2)
    s_waitcnt vmcnt(15)
    v_mfma_f32_32x32x16_bf16 v[16:31], v[120:123], v[104:107], v[16:31]
    v_mfma_f32_32x32x16_bf16 v[32:47], v[124:127], v[104:107], v[32:47]
    s_mov_b32 s49, 368640
    buffer_load_dwordx4 v[104:107], v2, s[8:11], s49 offen sc1
    ds_read_b128 v[120:123], v9 offset:0
    ds_read_b128 v[124:127], v10 offset:0
    s_waitcnt lgkmcnt(2)
    s_waitcnt vmcnt(15)
    v_mfma_f32_32x32x16_bf16 v[16:31], v[128:131], v[108:111], v[16:31]
    v_mfma_f32_32x32x16_bf16 v[32:47], v[132:135], v[108:111], v[32:47]
    s_mov_b32 s49, 380928
    buffer_load_dwordx4 v[108:111], v2, s[8:11], s49 offen sc1
    ds_read_b128 v[128:131], v9 offset:2048
    ds_read_b128 v[132:135], v10 offset:2048
    s_waitcnt lgkmcnt(2)
    s_waitcnt vmcnt(15)
    v_mfma_f32_32x32x16_bf16 v[16:31], v[120:123], v[48:51], v[16:31]
    v_mfma_f32_32x32x16_bf16 v[32:47], v[124:127], v[48:51], v[32:47]
    ds_read_b128 v[120:123], v9 offset:4096
    ds_read_b128 v[124:127], v10 offset:4096
    s_waitcnt lgkmcnt(2)
    s_waitcnt vmcnt(14)
    v_mfma_f32_32x32x16_bf16 v[16:31], v[128:131], v[52:55], v[16:31]
    v_mfma_f32_32x32x16_bf16 v[32:47], v[132:135], v[52:55], v[32:47]
    ds_read_b128 v[128:131], v9 offset:6144
    ds_read_b128 v[132:135], v10 offset:6144
    s_waitcnt lgkmcnt(2)
    s_waitcnt vmcnt(13)
    v_mfma_f32_32x32x16_bf16 v[16:31], v[120:123], v[56:59], v[16:31]
    v_mfma_f32_32x32x16_bf16 v[32:47], v[124:127], v[56:59], v[32:47]
    ds_read_b128 v[120:123], v9 offset:8192
    ds_read_b128 v[124:127], v10 offset:8192
    s_waitcnt lgkmcnt(2)
    s_waitcnt vmcnt(12)
    v_mfma_f32_32x32x16_bf16 v[16:31], v[128:131], v[60:63], v[16:31]
    v_mfma_f32_32x32x16_bf16 v[32:47], v[132:135], v[60:63], v[32:47]
    ds_read_b128 v[128:131], v9 offset:10240
    ds_read_b128 v[132:135], v10 offset:10240
    s_waitcnt lgkmcnt(2)
    s_waitcnt vmcnt(11)
    v_mfma_f32_32x32x16_bf16 v[16:31], v[120:123], v[64:67], v[16:31]
    v_mfma_f32_32x32x16_bf16 v[32:47], v[124:127], v[64:67], v[32:47]
    ds_read_b128 v[120:123], v9 offset:12288
    ds_read_b128 v[124:127], v10 offset:12288
    s_waitcnt lgkmcnt(2)
    s_waitcnt vmcnt(10)
    v_mfma_f32_32x32x16_bf16 v[16:31], v[128:131], v[68:71], v[16:31]
    v_mfma_f32_32x32x16_bf16 v[32:47], v[132:135], v[68:71], v[32:47]
    ds_read_b128 v[128:131], v9 offset:14336
    ds_read_b128 v[132:135], v10 offset:14336
    s_waitcnt lgkmcnt(2)
    s_waitcnt vmcnt(9)
    v_mfma_f32_32x32x16_bf16 v[16:31], v[120:123], v[72:75], v[16:31]
    v_mfma_f32_32x32x16_bf16 v[32:47], v[124:127], v[72:75], v[32:47]
    ds_read_b128 v[120:123], v9 offset:32768
    ds_read_b128 v[124:127], v10 offset:32768
    s_waitcnt lgkmcnt(2)
    s_waitcnt vmcnt(8)
    v_mfma_f32_32x32x16_bf16 v[16:31], v[128:131], v[76:79], v[16:31]
    v_mfma_f32_32x32x16_bf16 v[32:47], v[132:135], v[76:79], v[32:47]
    ds_read_b128 v[128:131], v9 offset:34816
    ds_read_b128 v[132:135], v10 offset:34816
    s_waitcnt lgkmcnt(2)
    s_waitcnt vmcnt(7)
    v_mfma_f32_32x32x16_bf16 v[16:31], v[120:123], v[80:83], v[16:31]
    v_mfma_f32_32x32x16_bf16 v[32:47], v[124:127], v[80:83], v[32:47]
    ds_read_b128 v[120:123], v9 offset:36864
    ds_read_b128 v[124:127], v10 offset:36864
    s_waitcnt lgkmcnt(2)
    s_waitcnt vmcnt(6)
    v_mfma_f32_32x32x16_bf16 v[16:31], v[128:131], v[84:87], v[16:31]
    v_mfma_f32_32x32x16_bf16 v[32:47], v[132:135], v[84:87], v[32:47]
    ds_read_b128 v[128:131], v9 offset:38912
    ds_read_b128 v[132:135], v10 offset:38912
    s_waitcnt lgkmcnt(2)
    s_waitcnt vmcnt(5)
    v_mfma_f32_32x32x16_bf16 v[16:31], v[120:123], v[88:91], v[16:31]
    v_mfma_f32_32x32x16_bf16 v[32:47], v[124:127], v[88:91], v[32:47]
    ds_read_b128 v[120:123], v9 offset:40960
    ds_read_b128 v[124:127], v10 offset:40960
    s_waitcnt lgkmcnt(2)
    s_waitcnt vmcnt(4)
    v_mfma_f32_32x32x16_bf16 v[16:31], v[128:131], v[92:95], v[16:31]
    v_mfma_f32_32x32x16_bf16 v[32:47], v[132:135], v[92:95], v[32:47]
    ds_read_b128 v[128:131], v9 offset:43008
    ds_read_b128 v[132:135], v10 offset:43008
    s_waitcnt lgkmcnt(2)
    s_waitcnt vmcnt(3)
    v_mfma_f32_32x32x16_bf16 v[16:31], v[120:123], v[96:99], v[16:31]
    v_mfma_f32_32x32x16_bf16 v[32:47], v[124:127], v[96:99], v[32:47]
    ds_read_b128 v[120:123], v9 offset:45056
    ds_read_b128 v[124:127], v10 offset:45056
    s_waitcnt lgkmcnt(2)
    s_waitcnt vmcnt(2)
    v_mfma_f32_32x32x16_bf16 v[16:31], v[128:131], v[100:103], v[16:31]
    v_mfma_f32_32x32x16_bf16 v[32:47], v[132:135], v[100:103], v[32:47]
    ds_read_b128 v[128:131], v9 offset:47104
    ds_read_b128 v[132:135], v10 offset:47104
    s_waitcnt lgkmcnt(2)
    s_waitcnt vmcnt(1)
    v_mfma_f32_32x32x16_bf16 v[16:31], v[120:123], v[104:107], v[16:31]
    v_mfma_f32_32x32x16_bf16 v[32:47], v[124:127], v[104:107], v[32:47]
    s_waitcnt lgkmcnt(0)
    s_waitcnt vmcnt(0)
    v_mfma_f32_32x32x16_bf16 v[16:31], v[128:131], v[108:111], v[16:31]
    v_mfma_f32_32x32x16_bf16 v[32:47], v[132:135], v[108:111], v[32:47]
    s_barrier
    s_lshl_b32 s53, s33, 12
    v_add_u32 v12, s53, v3
    s_nop 8
    ds_write_b128 v12, v[32:35] offset:0
    ds_write_b128 v12, v[36:39] offset:1024
    ds_write_b128 v12, v[40:43] offset:2048
    ds_write_b128 v12, v[44:47] offset:3072
    s_xor_b32 s53, s33, 4
    s_lshl_b32 s53, s53, 12
    v_add_u32 v12, s53, v3
    s_waitcnt lgkmcnt(0)
    s_barrier
    ds_read_b128 v[32:35], v12 offset:0
    ds_read_b128 v[36:39], v12 offset:1024
    ds_read_b128 v[40:43], v12 offset:2048
    ds_read_b128 v[44:47], v12 offset:3072
    v_lshlrev_b32 v72, 16, v112
    v_and_b32 v73, s39, v112
    v_lshlrev_b32 v74, 16, v113
    v_and_b32 v75, s39, v113
    v_lshlrev_b32 v76, 16, v114
    v_and_b32 v77, s39, v114
    v_lshlrev_b32 v78, 16, v115
    v_and_b32 v79, s39, v115
    v_lshlrev_b32 v80, 16, v116
    v_and_b32 v81, s39, v116
    v_lshlrev_b32 v82, 16, v117
    v_and_b32 v83, s39, v117
    v_lshlrev_b32 v84, 16, v118
    v_and_b32 v85, s39, v118
    v_lshlrev_b32 v86, 16, v119
    v_and_b32 v87, s39, v119
    v_add_f32 v16, v16, v72
    v_add_f32 v17, v17, v73
    v_add_f32 v18, v18, v74
    v_add_f32 v19, v19, v75
    v_add_f32 v20, v20, v76
    v_add_f32 v21, v21, v77
    v_add_f32 v22, v22, v78
    v_add_f32 v23, v23, v79
    v_add_f32 v24, v24, v80
    v_add_f32 v25, v25, v81
    v_add_f32 v26, v26, v82
    v_add_f32 v27, v27, v83
    v_add_f32 v28, v28, v84
    v_add_f32 v29, v29, v85
    v_add_f32 v30, v30, v86
    v_add_f32 v31, v31, v87
    s_waitcnt lgkmcnt(0)
    v_add_f32 v56, v16, v32
    v_add_f32 v57, v17, v33
    v_add_f32 v58, v18, v34
    v_add_f32 v59, v19, v35
    v_add_f32 v60, v20, v36
    v_add_f32 v61, v21, v37
    v_add_f32 v62, v22, v38
    v_add_f32 v63, v23, v39
    v_add_f32 v64, v24, v40
    v_add_f32 v65, v25, v41
    v_add_f32 v66, v26, v42
    v_add_f32 v67, v27, v43
    v_add_f32 v68, v28, v44
    v_add_f32 v69, v29, v45
    v_add_f32 v70, v30, v46
    v_add_f32 v71, v31, v47
    v_cvt_pk_bf16_f32 v48, v56, v57
    v_cvt_pk_bf16_f32 v49, v58, v59
    v_cvt_pk_bf16_f32 v50, v60, v61
    v_cvt_pk_bf16_f32 v51, v62, v63
    v_cvt_pk_bf16_f32 v52, v64, v65
    v_cvt_pk_bf16_f32 v53, v66, v67
    v_cvt_pk_bf16_f32 v54, v68, v69
    v_cvt_pk_bf16_f32 v55, v70, v71
    v_permlane32_swap_b32 v48, v50
    v_permlane32_swap_b32 v49, v51
    v_permlane32_swap_b32 v52, v54
    v_permlane32_swap_b32 v53, v55
    s_cmp_lg_u32 s32, 0
    s_cbranch_scc1 Lkblast59
    s_cmp_eq_u32 s36, 0
    s_cbranch_scc1 Lst60
    s_mov_b32 s42, 28311552
    s_mov_b32 s43, 28323840
    buffer_store_dwordx4 v[48:51], v11, s[8:11], s42 offen
    buffer_store_dwordx4 v[52:55], v11, s[8:11], s43 offen
    s_branch Lsd61
Lst60:
    s_mov_b32 s42, 28311552
    s_mov_b32 s43, 28323840
    buffer_store_dwordx4 v[48:51], v11, s[8:11], s42 offen sc1
    buffer_store_dwordx4 v[52:55], v11, s[8:11], s43 offen sc1
Lsd61:
    s_waitcnt vmcnt(0)
    s_barrier
    s_cmp_lg_u32 s33, 0
    s_cbranch_scc1 Lpb62
    s_lshl_b32 s42, s34, 8
    s_lshl_b32 s43, s35, 3
    s_add_u32 s42, s42, s43
    s_add_u32 s42, s42, 48246784
    v_mov_b32 v230, s42
    v_mov_b32 v232, s6
    v_mov_b32 v233, s7
    s_mov_b64 exec, 1
    s_cmp_eq_u32 s36, 0
    s_cbranch_scc1 Lst63
    buffer_store_dwordx2 v[232:233], v230, s[8:11], 0 offen
    s_branch Lsd64
Lst63:
    buffer_store_dwordx2 v[232:233], v230, s[8:11], 0 offen sc1
Lsd64:
    s_mov_b64 exec, -1
Lpb62:
    s_branch Le22
Lkblast59:
    s_load_dwordx2 s[12:13], s[0:1], 80
    s_mov_b32 s14, 4194304
    s_lshl_b32 s50, s59, 5
    v_add_u32 v12, s50, v5
    s_lshl_b32 s51, s60, 2
    v_add_u32 v13, s51, v6
    v_and_b32 v14, 7, v12
    v_xor_b32 v15, v13, v14
    v_lshlrev_b32 v15, 4, v15
    v_lshl_add_u32 v15, v12, 7, v15
    v_add_u32 v13, 2, v13
    v_xor_b32 v13, v13, v14
    v_lshlrev_b32 v13, 4, v13
    v_lshl_add_u32 v13, v12, 7, v13
    ds_write_b128 v15, v[48:51] offset:40960
    ds_write_b128 v13, v[52:55] offset:40960
    v_lshrrev_b32 v12, 3, v0
    v_and_b32 v13, 7, v0
    v_and_b32 v14, 7, v12
    v_xor_b32 v14, v14, v13
    v_lshlrev_b32 v14, 4, v14
    v_lshl_add_u32 v14, v12, 7, v14
    s_and_b32 s42, s35, 1
    s_lshl_b32 s43, s34, 1
    s_add_u32 s42, s42, s43
    s_lshl_b32 s42, s42, 7
    v_add_u32 v15, s42, v12
    v_lshlrev_b32 v15, 11, v15
    v_lshl_add_u32 v15, v13, 4, v15
    s_lshl_b32 s50, s58, 7
    v_add_u32 v15, s50, v15
    s_mov_b32 s51, 131072
    s_waitcnt lgkmcnt(0)
    s_barrier
    ds_read_b128 v[16:19], v14 offset:40960
    ds_read_b128 v[20:23], v14 offset:49152
    s_waitcnt lgkmcnt(0)
    buffer_store_dwordx4 v[16:19], v15, s[12:15], 0 offen
    buffer_store_dwordx4 v[20:23], v15, s[12:15], s51 offen
    s_branch Ldone1
Le22:
    v_and_b32 v1, 7, v0
    v_lshrrev_b32 v2, 3, v0
    s_lshl_b32 s42, s34, 8
    s_lshl_b32 s43, s35, 3
    s_add_u32 s42, s42, s43
    v_add_u32 v3, s42, v1
    v_lshrrev_b32 v4, 6, v0
    v_mul_u32_u24 v5, 6144, v2
    v_lshl_add_u32 v5, v1, 4, v5
    s_mul_i32 s44, s34, 786432
    s_lshl_b32 s45, s35, 7
    s_add_u32 s44, s44, s45
    v_add_u32 v5, s44, v5
    v_mul_u32_u24 v7, 33024, v2
    v_lshl_add_u32 v7, v3, 3, v7
    v_lshlrev_b32 v96, 6, v1
    v_add_u32 v96, 161792, v96
    v_lshl_add_u32 v97, v4, 3, v96
    s_mul_i32 s56, s35, 196608
    s_mul_i32 s57, s33, 3072
    s_add_u32 s56, s56, s57
    v_and_b32 v236, 63, v0
    v_lshl_add_u32 v236, v236, 4, s56
    s_cmp_lg_u32 s33, 0
    s_cbranch_scc1 Lwo65
    v_and_b32 v200, 63, v0
    v_and_b32 v200, 31, v200
    v_lshlrev_b32 v200, 3, v200
    s_lshl_b32 s42, s34, 8
    s_add_u32 s42, s42, 48246784
    v_add_u32 v200, s42, v200
    s_mov_b32 s43, 0
Lpl68:
    buffer_load_dwordx2 v[202:203], v200, s[8:11], 0 offen sc1
    s_add_u32 s43, s43, 1
    s_cmp_gt_u32 s43, 500000
    s_cbranch_scc1 Lwf67
    s_waitcnt vmcnt(0)
    v_and_b32 v201, -16, v202
    v_xor_b32 v201, s6, v201
    v_xor_b32 v204, s7, v203
    v_or_b32 v201, v201, v204
    v_cmp_ne_u32 vcc, 0, v201
    s_cbranch_vccnz Lpl68
Lwf67:
    s_waitcnt vmcnt(0)
    s_mov_b32 s42, 7340032
    s_mov_b32 s43, 7356544
    s_mov_b32 s44, 9453568
    s_mov_b32 s45, 9470080
    buffer_load_dwordx2 v[16:17], v7, s[8:11], s42 offen
    buffer_load_dwordx2 v[18:19], v7, s[8:11], s43 offen
    buffer_load_dwordx2 v[20:21], v7, s[8:11], s44 offen
    buffer_load_dwordx2 v[22:23], v7, s[8:11], s45 offen
    s_branch Lwj66
Lwo65:
    s_mov_b32 s42, 7340032
    s_mov_b32 s43, 7356544
    s_mov_b32 s44, 9453568
    s_mov_b32 s45, 9470080
    buffer_load_dwordx2 v[16:17], v7, s[8:11], s42 offen
    buffer_load_dwordx2 v[18:19], v7, s[8:11], s43 offen
    buffer_load_dwordx2 v[20:21], v7, s[8:11], s44 offen
    buffer_load_dwordx2 v[22:23], v7, s[8:11], s45 offen
Lwj66:
    s_barrier
    s_mov_b32 s42, 28311552
    s_mov_b32 s43, 28704768
    buffer_load_dwordx4 v[8:11], v5, s[8:11], s42 offen sc1
    buffer_load_dwordx4 v[12:15], v5, s[8:11], s43 offen sc1
    s_mul_i32 s42, s34, 786432
    s_lshl_b32 s43, s35, 7
    s_add_u32 s42, s42, s43
    s_mul_i32 s43, s33, 98304
    s_add_u32 s42, s42, s43
    s_add_u32 s42, s42, 0
    v_and_b32 v239, 15, v0
    v_mul_u32_u24 v238, 6144, v239
    v_add_u32 v238, s42, v238
    s_mov_b64 exec, 0xffff
    buffer_load_dword v239, v238, s[8:11], 0 offen sc1
    s_mov_b64 exec, -1
    s_waitcnt vmcnt(3)
    v_lshlrev_b32 v64, 16, v16
    v_and_b32 v65, s39, v16
    v_lshlrev_b32 v66, 16, v17
    v_and_b32 v67, s39, v17
    v_lshlrev_b32 v68, 16, v18
    v_and_b32 v69, s39, v18
    v_lshlrev_b32 v70, 16, v19
    v_and_b32 v71, s39, v19
    v_lshlrev_b32 v72, 16, v20
    v_and_b32 v73, s39, v20
    v_lshlrev_b32 v74, 16, v21
    v_and_b32 v75, s39, v21
    v_lshlrev_b32 v76, 16, v22
    v_and_b32 v77, s39, v22
    v_lshlrev_b32 v78, 16, v23
    v_and_b32 v79, s39, v23
    s_waitcnt vmcnt(1)
    v_lshlrev_b32 v24, 16, v8
    v_and_b32 v25, s39, v8
    v_lshlrev_b32 v26, 16, v9
    v_and_b32 v27, s39, v9
    v_lshlrev_b32 v28, 16, v10
    v_and_b32 v29, s39, v10
    v_lshlrev_b32 v30, 16, v11
    v_and_b32 v31, s39, v11
    v_lshlrev_b32 v32, 16, v12
    v_and_b32 v33, s39, v12
    v_lshlrev_b32 v34, 16, v13
    v_and_b32 v35, s39, v13
    v_lshlrev_b32 v36, 16, v14
    v_and_b32 v37, s39, v14
    v_lshlrev_b32 v38, 16, v15
    v_and_b32 v39, s39, v15
    v_add_f32 v98, v24, v25
    v_add_f32 v102, v26, v27
    v_mul_f32 v99, v24, v24
    v_mul_f32 v103, v25, v25
    v_fmac_f32 v99, v26, v26
    v_fmac_f32 v103, v27, v27
    v_add_f32 v98, v98, v28
    v_add_f32 v102, v102, v29
    v_fmac_f32 v99, v28, v28
    v_fmac_f32 v103, v29, v29
    v_add_f32 v98, v98, v30
    v_add_f32 v102, v102, v31
    v_fmac_f32 v99, v30, v30
    v_fmac_f32 v103, v31, v31
    v_add_f32 v98, v98, v32
    v_add_f32 v102, v102, v33
    v_fmac_f32 v99, v32, v32
    v_fmac_f32 v103, v33, v33
    v_add_f32 v98, v98, v34
    v_add_f32 v102, v102, v35
    v_fmac_f32 v99, v34, v34
    v_fmac_f32 v103, v35, v35
    v_add_f32 v98, v98, v36
    v_add_f32 v102, v102, v37
    v_fmac_f32 v99, v36, v36
    v_fmac_f32 v103, v37, v37
    v_add_f32 v98, v98, v38
    v_add_f32 v102, v102, v39
    v_fmac_f32 v99, v38, v38
    v_fmac_f32 v103, v39, v39
    v_add_f32 v98, v98, v102
    v_add_f32 v99, v99, v103
    s_nop 0
    v_add_f32_dpp v98, v98, v98 row_ror:8 row_mask:0xf bank_mask:0xf
    v_add_f32_dpp v99, v99, v99 row_ror:8 row_mask:0xf bank_mask:0xf
    v_mov_b32 v102, v98
    v_mov_b32 v103, v99
    s_nop 0
    v_permlane16_swap_b32 v98, v102
    v_permlane16_swap_b32 v99, v103
    v_add_f32 v98, v98, v102
    v_add_f32 v99, v99, v103
    v_mov_b32 v102, v98
    v_mov_b32 v103, v99
    s_nop 0
    v_permlane32_swap_b32 v98, v102
    v_permlane32_swap_b32 v99, v103
    v_add_f32 v98, v98, v102
    v_add_f32 v99, v99, v103
    ds_write_b64 v97, v[98:99] offset:0
    s_waitcnt lgkmcnt(0)
    s_barrier
    ds_read_b128 v[104:107], v96 offset:0
    ds_read_b128 v[108:111], v96 offset:16
    ds_read_b128 v[112:115], v96 offset:32
    ds_read_b128 v[116:119], v96 offset:48
    s_waitcnt lgkmcnt(0)
    v_add_f32 v104, v104, v106
    v_add_f32 v105, v105, v107
    v_add_f32 v108, v108, v110
    v_add_f32 v109, v109, v111
    v_add_f32 v112, v112, v114
    v_add_f32 v113, v113, v115
    v_add_f32 v116, v116, v118
    v_add_f32 v117, v117, v119
    v_add_f32 v104, v104, v108
    v_add_f32 v105, v105, v109
    v_add_f32 v112, v112, v116
    v_add_f32 v113, v113, v117
    v_add_f32 v104, v104, v112
    v_add_f32 v105, v105, v113
    v_mul_f32 v104, 0x3a800000, v104
    v_mul_f32 v105, 0x3a800000, v105
    v_fma_f32 v105, -v104, v104, v105
    v_max_f32 v105, 0, v105
    v_add_f32 v105, 0x3727c5ac, v105
    v_rsq_f32 v100, v105
    v_mul_f32 v102, -1.0, v104
    v_mov_b32 v101, v100
    v_mul_f32 v102, v102, v100
    v_mov_b32 v103, v102
    v_pk_fma_f32 v[40:41], v[24:25], v[100:101], v[102:103]
    v_pk_fma_f32 v[42:43], v[26:27], v[100:101], v[102:103]
    v_pk_fma_f32 v[44:45], v[28:29], v[100:101], v[102:103]
    v_pk_fma_f32 v[46:47], v[30:31], v[100:101], v[102:103]
    v_pk_fma_f32 v[48:49], v[32:33], v[100:101], v[102:103]
    v_pk_fma_f32 v[50:51], v[34:35], v[100:101], v[102:103]
    v_pk_fma_f32 v[52:53], v[36:37], v[100:101], v[102:103]
    v_pk_fma_f32 v[54:55], v[38:39], v[100:101], v[102:103]
    v_fmac_f32 v24, v40, v64
    v_fmac_f32 v25, v41, v65
    v_fmac_f32 v26, v42, v66
    v_fmac_f32 v27, v43, v67
    v_fmac_f32 v28, v44, v68
    v_fmac_f32 v29, v45, v69
    v_fmac_f32 v30, v46, v70
    v_fmac_f32 v31, v47, v71
    v_fmac_f32 v32, v48, v72
    v_fmac_f32 v33, v49, v73
    v_fmac_f32 v34, v50, v74
    v_fmac_f32 v35, v51, v75
    v_fmac_f32 v36, v52, v76
    v_fmac_f32 v37, v53, v77
    v_fmac_f32 v38, v54, v78
    v_fmac_f32 v39, v55, v79
    v_cvt_pk_bf16_f32 v80, v24, v25
    v_cvt_pk_bf16_f32 v81, v26, v27
    v_cvt_pk_bf16_f32 v82, v28, v29
    v_cvt_pk_bf16_f32 v83, v30, v31
    v_cvt_pk_bf16_f32 v84, v32, v33
    v_cvt_pk_bf16_f32 v85, v34, v35
    v_cvt_pk_bf16_f32 v86, v36, v37
    v_cvt_pk_bf16_f32 v87, v38, v39
    s_cmp_eq_u32 s36, 0
    s_cbranch_scc1 Lst69
    s_mov_b32 s42, 28311552
    s_mov_b32 s43, 28704768
    buffer_store_dwordx4 v[80:83], v5, s[8:11], s42 offen
    buffer_store_dwordx4 v[84:87], v5, s[8:11], s43 offen
    s_branch Lsd70
Lst69:
    s_mov_b32 s42, 28311552
    s_mov_b32 s43, 28704768
    buffer_store_dwordx4 v[80:83], v5, s[8:11], s42 offen sc1
    buffer_store_dwordx4 v[84:87], v5, s[8:11], s43 offen sc1
Lsd70:
    v_add_f32 v98, v24, v25
    v_add_f32 v102, v26, v27
    v_mul_f32 v99, v24, v24
    v_mul_f32 v103, v25, v25
    v_fmac_f32 v99, v26, v26
    v_fmac_f32 v103, v27, v27
    v_add_f32 v98, v98, v28
    v_add_f32 v102, v102, v29
    v_fmac_f32 v99, v28, v28
    v_fmac_f32 v103, v29, v29
    v_add_f32 v98, v98, v30
    v_add_f32 v102, v102, v31
    v_fmac_f32 v99, v30, v30
    v_fmac_f32 v103, v31, v31
    v_add_f32 v98, v98, v32
    v_add_f32 v102, v102, v33
    v_fmac_f32 v99, v32, v32
    v_fmac_f32 v103, v33, v33
    v_add_f32 v98, v98, v34
    v_add_f32 v102, v102, v35
    v_fmac_f32 v99, v34, v34
    v_fmac_f32 v103, v35, v35
    v_add_f32 v98, v98, v36
    v_add_f32 v102, v102, v37
    v_fmac_f32 v99, v36, v36
    v_fmac_f32 v103, v37, v37
    v_add_f32 v98, v98, v38
    v_add_f32 v102, v102, v39
    v_fmac_f32 v99, v38, v38
    v_fmac_f32 v103, v39, v39
    v_add_f32 v98, v98, v102
    v_add_f32 v99, v99, v103
    s_nop 0
    v_add_f32_dpp v98, v98, v98 row_ror:8 row_mask:0xf bank_mask:0xf
    v_add_f32_dpp v99, v99, v99 row_ror:8 row_mask:0xf bank_mask:0xf
    v_mov_b32 v102, v98
    v_mov_b32 v103, v99
    s_nop 0
    v_permlane16_swap_b32 v98, v102
    v_permlane16_swap_b32 v99, v103
    v_add_f32 v98, v98, v102
    v_add_f32 v99, v99, v103
    v_mov_b32 v102, v98
    v_mov_b32 v103, v99
    s_nop 0
    v_permlane32_swap_b32 v98, v102
    v_permlane32_swap_b32 v99, v103
    v_add_f32 v98, v98, v102
    v_add_f32 v99, v99, v103
    ds_write_b64 v97, v[98:99] offset:512
    s_waitcnt lgkmcnt(0)
    s_barrier
    ds_read_b128 v[104:107], v96 offset:512
    ds_read_b128 v[108:111], v96 offset:528
    ds_read_b128 v[112:115], v96 offset:544
    ds_read_b128 v[116:119], v96 offset:560
    s_waitcnt lgkmcnt(0)
    v_add_f32 v104, v104, v106
    v_add_f32 v105, v105, v107
    v_add_f32 v108, v108, v110
    v_add_f32 v109, v109, v111
    v_add_f32 v112, v112, v114
    v_add_f32 v113, v113, v115
    v_add_f32 v116, v116, v118
    v_add_f32 v117, v117, v119
    v_add_f32 v104, v104, v108
    v_add_f32 v105, v105, v109
    v_add_f32 v112, v112, v116
    v_add_f32 v113, v113, v117
    v_add_f32 v104, v104, v112
    v_add_f32 v105, v105, v113
    v_mul_f32 v104, 0x3a800000, v104
    v_mul_f32 v105, 0x3a800000, v105
    v_fma_f32 v105, -v104, v104, v105
    v_max_f32 v105, 0, v105
    v_add_f32 v105, 0x3727c5ac, v105
    v_rsq_f32 v100, v105
    v_mul_f32 v102, -1.0, v104
    v_mov_b32 v101, v100
    v_mul_f32 v102, v102, v100
    v_mov_b32 v103, v102
    v_pk_fma_f32 v[40:41], v[24:25], v[100:101], v[102:103]
    v_pk_fma_f32 v[42:43], v[26:27], v[100:101], v[102:103]
    v_pk_fma_f32 v[44:45], v[28:29], v[100:101], v[102:103]
    v_pk_fma_f32 v[46:47], v[30:31], v[100:101], v[102:103]
    v_pk_fma_f32 v[48:49], v[32:33], v[100:101], v[102:103]
    v_pk_fma_f32 v[50:51], v[34:35], v[100:101], v[102:103]
    v_pk_fma_f32 v[52:53], v[36:37], v[100:101], v[102:103]
    v_pk_fma_f32 v[54:55], v[38:39], v[100:101], v[102:103]
    v_cvt_pk_bf16_f32 v56, v40, v41
    v_cvt_pk_bf16_f32 v57, v42, v43
    v_cvt_pk_bf16_f32 v58, v44, v45
    v_cvt_pk_bf16_f32 v59, v46, v47
    v_cvt_pk_bf16_f32 v60, v48, v49
    v_cvt_pk_bf16_f32 v61, v50, v51
    v_cvt_pk_bf16_f32 v62, v52, v53
    v_cvt_pk_bf16_f32 v63, v54, v55
    s_cmp_eq_u32 s36, 0
    s_cbranch_scc1 Lst71
    s_mov_b32 s42, 0
    s_mov_b32 s43, 393216
    buffer_store_dwordx4 v[56:59], v5, s[8:11], s42 offen
    buffer_store_dwordx4 v[60:63], v5, s[8:11], s43 offen
    s_branch Lsd72
Lst71:
    s_mov_b32 s42, 0
    s_mov_b32 s43, 393216
    buffer_store_dwordx4 v[56:59], v5, s[8:11], s42 offen sc1
    buffer_store_dwordx4 v[60:63], v5, s[8:11], s43 offen sc1
Lsd72:
    s_waitcnt vmcnt(0)
    s_barrier
    s_cmp_lg_u32 s33, 0
    s_cbranch_scc1 Lpb73
    s_lshl_b32 s42, s34, 8
    s_lshl_b32 s43, s35, 3
    s_add_u32 s42, s42, s43
    s_add_u32 s42, s42, 48240640
    v_mov_b32 v230, s42
    v_mov_b32 v232, s6
    v_mov_b32 v233, s7
    s_mov_b64 exec, 1
    s_cmp_eq_u32 s36, 0
    s_cbranch_scc1 Lst74
    buffer_store_dwordx2 v[232:233], v230, s[8:11], 0 offen
    s_branch Lsd75
Lst74:
    buffer_store_dwordx2 v[232:233], v230, s[8:11], 0 offen sc1
Lsd75:
    s_mov_b64 exec, -1
Lpb73:
    s_mov_b32 s32, 1
    s_branch Llayer3
Ldone1:
    s_waitcnt vmcnt(0) lgkmcnt(0)
interleave_layers__ssm_conv_h3__linear_kernel_hedgehog__prompt_kernel_end:
    s_endpgm
.section .rodata,"a"
.p2align 6
.amdhsa_kernel interleave_layers__ssm_conv_h3__linear_kernel_hedgehog__prompt_kernel
  .amdhsa_next_free_vgpr 256
  .amdhsa_next_free_sgpr 102
  .amdhsa_accum_offset 256
  .amdhsa_group_segment_fixed_size 0
  .amdhsa_kernarg_size 104
  .amdhsa_user_sgpr_count 2
  .amdhsa_user_sgpr_kernarg_segment_ptr 1
  .amdhsa_system_sgpr_workgroup_id_x 1
.end_amdhsa_kernel
```
